```python
import torch

def _softmax(x, axis=-1):
    return torch.softmax(x, dim=axis)
def _gelu(x):
    return torch.nn.functional.gelu(x, approximate="tanh")
def _silu(x):
    return torch.nn.functional.silu(x)
def _sigmoid(x):
    return torch.sigmoid(x)
def _layernorm(x, axis=-1, eps=1e-5):
    m = x.mean(dim=axis, keepdim=True)
    v = x.var(dim=axis, keepdim=True, unbiased=False)
    return (x - m) / torch.sqrt(v + eps)
def _scatter_add(tgt, idx, src, axis=0):
    return tgt.clone().index_add_(axis, idx, src)
def _segment_sum(src, seg, n):
    out = torch.zeros((n,) + src.shape[1:], dtype=src.dtype)
    return out.index_add_(0, seg, src)
def _pad(x, pw):
    flat = tuple(v for pair in reversed(pw) for v in pair)
    return torch.nn.functional.pad(x, flat)

kernel_name = 'parallel_sum__ssm_conv_s4__glu_gated_geglu__prompt'

def setup_inputs():

    _w = (lambda a: (lambda t: t.to(torch.bfloat16) if t.is_floating_point() else t)(torch.as_tensor(a)))
    def _A_setup():
        B, L, D, N = 1, 2048, 448, 256
        A_re = -(lambda _x: torch.exp(torch.as_tensor(_x)))((lambda *s: torch.randn(*s, dtype=torch.bfloat16) * 6.4)(D, N))
        A_im = torch.pi * (lambda *s: torch.randn(*s, dtype=torch.bfloat16) * 0.05)(D, N)
        B_re = (lambda *s: torch.randn(*s, dtype=torch.bfloat16) * 0.1)(D, N)
        B_im = (lambda *s: torch.randn(*s, dtype=torch.bfloat16) * 0.1)(D, N)
        C_re = (lambda *s: torch.randn(*s, dtype=torch.bfloat16) * 0.1)(D, N)
        C_im = (lambda *s: torch.randn(*s, dtype=torch.bfloat16) * 0.1)(D, N)
        log_dt = (lambda *s: torch.randn(*s, dtype=torch.bfloat16) * 0.05)(D) * 0.5 - 4.0
        Dskip = (lambda *s: torch.randn(*s, dtype=torch.bfloat16) * 0.05)(D)
        return {
            "u": _w((lambda *s: torch.randn(*s, dtype=torch.bfloat16) * 0.05)(B, L, D)),
            "A_re": _w(A_re),
            "A_im": _w(A_im),
            "B_re": _w(B_re),
            "B_im": _w(B_im),
            "C_re": _w(C_re),
            "C_im": _w(C_im),
            "log_dt": _w(log_dt),
            "Dskip": _w(Dskip),
        }
    _A_in = _A_setup()

    def _B_setup():
        B, S, Dm, Df = 1, 2048, 448, 1792
        return {
            "x": _w((lambda *s: torch.randn(*s, dtype=torch.bfloat16) * 0.05)(B, S, Dm)),
            "w_gate": _w((lambda *s: torch.randn(*s, dtype=torch.bfloat16) * 0.4)(Dm, Df) * (Dm ** -0.5)),
            "w_up": _w((lambda *s: torch.randn(*s, dtype=torch.bfloat16) * 0.4)(Dm, Df) * (Dm ** -0.5)),
            "w_down": _w((lambda *s: torch.randn(*s, dtype=torch.bfloat16) * 0.4)(Df, Dm) * (Df ** -0.5)),
        }
    _B_in = _B_setup()

    return {
        "A_u": _A_in["u"],
        "A_A_re": _A_in["A_re"],
        "A_A_im": _A_in["A_im"],
        "A_B_re": _A_in["B_re"],
        "A_B_im": _A_in["B_im"],
        "A_C_re": _A_in["C_re"],
        "A_C_im": _A_in["C_im"],
        "A_log_dt": _A_in["log_dt"],
        "A_Dskip": _A_in["Dskip"],
        "B_x": _B_in["x"],
        "B_w_gate": _B_in["w_gate"],
        "B_w_up": _B_in["w_up"],
        "B_w_down": _B_in["w_down"],
    }

def reference(A_u, A_A_re, A_A_im, A_B_re, A_B_im, A_C_re, A_C_im, A_log_dt, A_Dskip, B_x, B_w_gate, B_w_up, B_w_down):
    def _A_ref(u, A_re, A_im, B_re, B_im, C_re, C_im, log_dt, Dskip):
        Bsz, L, D = u.shape
        dt = torch.exp(log_dt)[:, None]
        A = A_re + 1j * A_im
        Bc = B_re + 1j * B_im
        Cc = C_re + 1j * C_im
        logdA = dt * A
        dB = dt * Bc
        l = (lambda x, dt: x.to(dt))(torch.arange(L), A_re.dtype)
        P = torch.exp(logdA[:, :, None] * l[None, None, :])
        K = torch.einsum("dn,dnl,dn->dl", Cc, P, dB).real
        L2 = 2 * L
        Kp = _pad(K, ((0, 0), (0, L)))
        up = (lambda x, *d: x.permute(*d))(u, 0, 2, 1)
        up = _pad(up, ((0, 0), (0, 0), (0, L)))
        Kf = (lambda x, axes=(-2,-1): torch.fft.rfft2(x.float(), dim=axes))(Kp[:, None, :], axes=(-2, -1))
        Uf = (lambda x, axes=(-2,-1): torch.fft.rfft2(x.float(), dim=axes))(up[:, :, None, :], axes=(-2, -1))
        Yf = Uf * Kf[None, :, :, :]
        y = (lambda x, s, axes=(-2,-1): torch.fft.irfft2(x, s=s, dim=axes).to(torch.bfloat16))(Yf, (1, L2), axes=(-2, -1))[:, :, 0, :L]
        y = (lambda x, *d: x.permute(*d))(y, 0, 2, 1) + u * Dskip[None, None, :]
        return y

    def _B_ref(x, w_gate, w_up, w_down):
        g = torch.einsum("bsd,df->bsf", x, w_gate)
        u = torch.einsum("bsd,df->bsf", x, w_up)
        h = _gelu(g) * u
        return torch.einsum("bsf,fd->bsd", h, w_down)

    x = A_u
    xn = _layernorm(x, axis=-1)
    return x + _A_ref(xn, A_A_re, A_A_im, A_B_re, A_B_im, A_C_re, A_C_im, A_log_dt, A_Dskip) + _B_ref(xn, B_w_gate, B_w_up, B_w_down)
```

```asm
; @launch grid=(256,1,1) block=(512,1,1) lds=158976
.amdgcn_target "amdgcn-amd-amdhsa--gfx950"
.text
.globl parallel_sum__ssm_conv_s4__glu_gated_geglu__prompt_kernel
.p2align 8
.type parallel_sum__ssm_conv_s4__glu_gated_geglu__prompt_kernel,@function
parallel_sum__ssm_conv_s4__glu_gated_geglu__prompt_kernel:
    s_cmp_ge_u32 s2, 256
    s_cbranch_scc1 K_END
    s_load_dwordx16 s[16:31], s[0:1], 0
    s_load_dwordx4 s[32:35], s[0:1], 80
    s_load_dwordx8 s[8:15], s[0:1], 96
    v_lshrrev_b32 v1, 6, v0
    s_nop 0
    v_readfirstlane_b32 s68, v1
    v_and_b32 v1, 63, v0
    s_cmp_ge_u32 s2, 32
    s_cbranch_scc1 K_NPF
    s_getpc_b64 s[4:5]
K_PFB:
    s_and_b32 s6, s2, 24
    s_add_u32 s6, s6, s68
    v_lshl_add_u32 v2, s6, 4, v1
    v_lshlrev_b32 v2, 7, v2
    s_mov_b64 exec, 0xffff
    v_min_u32 v2, K_END-K_PFB, v2
    global_load_dword v255, v2, s[4:5]
    s_mov_b64 exec, -1
K_NPF:
    s_cmp_lt_u32 s2, 32
    s_cbranch_scc1 K_PROD
    s_and_b32 s76, s2, 7
    s_lshr_b32 s77, s2, 3
    s_sub_u32 s77, s77, 4
    s_lshr_b32 s78, s76, 1
    s_lshl_b32 s78, s78, 2
    s_and_b32 s79, s77, 3
    s_add_u32 s69, s78, s79
    s_andn2_b32 s78, 1, s76
    s_mul_i32 s78, s78, 7
    s_lshr_b32 s74, s77, 2
    s_add_u32 s70, s78, s74
    s_lshl_b32 s73, s76, 2
    s_add_u32 s73, s73, s79
    s_cmp_ge_u32 s68, 4
    s_cbranch_scc1 K_HELP
    s_setprio 2
    s_and_b32 s71, s68, 1
    s_lshr_b32 s72, s68, 1
    s_lshl_b32 s82, s68, 11
    s_lshl_b32 s80, s68, 12
    v_lshrrev_b32 v2, 3, v1
    s_lshl_b32 s76, s69, 7
    s_lshl_b32 s77, s68, 5
    s_add_u32 s76, s76, s77
    v_add_u32 v2, s76, v2
    v_mul_u32_u24 v2, 896, v2
    v_lshrrev_b32 v5, 4, v1
    v_xor_b32 v6, v1, v5
    v_and_b32 v6, 7, v6
    v_xor_b32 v7, 4, v6
    v_lshl_add_u32 v3, v7, 4, v2
    v_add_u32 v3, 6144, v3
    v_lshl_add_u32 v2, v6, 4, v2
    v_add_u32 v56, 12288, v2
    v_add_u32 v57, 12288, v3
    v_mul_u32_u24 v4, 3584, v5
    v_lshlrev_b32 v6, 2, v5
    v_xor_b32 v6, v1, v6
    v_and_b32 v6, 15, v6
    v_lshl_add_u32 v4, v6, 4, v4
    s_lshl_b32 s76, s70, 8
    s_mul_i32 s77, s68, 28672
    s_add_u32 s76, s76, s77
    v_add_u32 v4, s76, v4
    v_add_u32 v58, 12288, v4
    s_mul_i32 s36, s68, 4
    s_add_u32 s36, s36, 158720
    s_lshl_b32 s76, s79, 1
    s_add_u32 s76, s76, s74
    s_lshl_b32 s76, s76, 7
    s_waitcnt lgkmcnt(0)
    s_mov_b32 s40, s16
    s_and_b32 s41, s17, 0xffff
    s_mov_b32 s42, 0x1c0000
    s_mov_b32 s43, 0x00020000
    s_add_u32 m0, s80, 65536
    s_movk_i32 s6, 0
    buffer_load_dwordx4 v2, s[40:43], s6 offen offset:0 lds
    buffer_load_dwordx4 v3, s[40:43], s6 offen offset:1024 lds
    buffer_load_dwordx4 v56, s[40:43], s6 offen offset:2048 lds
    buffer_load_dwordx4 v57, s[40:43], s6 offen offset:3072 lds
    s_mov_b32 s44, s32
    s_and_b32 s45, s33, 0xffff
    s_mov_b32 s46, 0x188000
    s_mov_b32 s47, 0x00020000
    s_mov_b32 s48, s34
    s_and_b32 s49, s35, 0xffff
    s_mov_b32 s50, 0x188000
    s_mov_b32 s51, 0x00020000
    s_add_u32 m0, s80, 0
    s_mov_b32 s81, 0
    buffer_load_dwordx4 v4, s[44:47], s81 offen offset:0 lds
    buffer_load_dwordx4 v58, s[44:47], s81 offen offset:2048 lds
    s_add_u32 m0, s80, 1024
    s_nop 0
    buffer_load_dwordx4 v4, s[48:51], 0 offen offset:0 lds
    buffer_load_dwordx4 v58, s[48:51], 0 offen offset:2048 lds
    s_cmp_lg_u32 s15, 0
    s_cselect_b32 s76, 31, 30
    s_lshl_b32 s76, s76, 2
    v_mov_b32 v50, s76
    s_barrier
    s_add_u32 m0, s36, 0
    s_mov_b64 exec, 1
    global_load_lds_dword v50, s[0:1]
    s_mov_b64 exec, -1
    v_lshlrev_b32 v15, 2, v1
    v_and_b32 v11, 3, v1
    v_mul_u32_u24 v51, 4, v11
    v_add_u32 v11, 158208, v11
    s_add_u32 m0, s80, 16384
    s_mov_b32 s81, 114688
    buffer_load_dwordx4 v4, s[44:47], s81 offen offset:0 lds
    v_add_u32 v51, 158720, v51
    s_add_u32 s76, s68, 158208
    v_mov_b32 v12, s76
    v_add_u32 v13, 158336, v15
    s_mov_b32 s5, 113664
    buffer_load_dwordx4 v4, s[48:51], s5 offen offset:1024 lds
    v_cmp_eq_u32 vcc, 0, v1
    s_nop 1
    v_cndmask_b32 v12, v13, v12, vcc
    v_mov_b32 v10, 158216
    v_and_b32 v16, 31, v1
    buffer_load_dwordx4 v58, s[44:47], s81 offen offset:2048 lds
    s_lshl_b32 s76, s71, 6
    v_add_u32 v22, s76, v16
    v_lshrrev_b32 v17, 5, v1
    v_bfe_u32 v18, v1, 1, 3
    buffer_load_dwordx4 v58, s[48:51], s5 offen offset:3072 lds
    s_add_u32 m0, s36, 16
    s_mov_b64 exec, 1
    global_load_lds_dword v50, s[0:1]
    s_mov_b64 exec, -1
    v_xor_b32 v18, v17, v18
    v_lshlrev_b32 v5, 7, v22
    v_lshl_add_u32 v5, v18, 4, v5
    v_add_u32 v5, 65536, v5
    s_add_u32 m0, s80, 115712
    s_movk_i32 s6, 128
    buffer_load_dwordx4 v2, s[40:43], s6 offen offset:0 lds
    v_xor_b32 v6, 32, v5
    v_xor_b32 v7, 64, v5
    v_xor_b32 v8, 96, v5
    v_bfe_u32 v19, v1, 2, 2
    buffer_load_dwordx4 v3, s[40:43], s6 offen offset:1024 lds
    v_lshl_add_u32 v20, v17, 4, v19
    v_lshlrev_b32 v9, 8, v20
    v_bfe_u32 v20, v1, 4, 1
    v_lshlrev_b32 v20, 1, v20
    buffer_load_dwordx4 v56, s[40:43], s6 offen offset:2048 lds
    v_bfe_u32 v21, v1, 1, 1
    v_add_u32 v20, v20, v21
    s_lshl_b32 s76, s72, 3
    v_add_u32 v20, s76, v20
    buffer_load_dwordx4 v57, s[40:43], s6 offen offset:3072 lds
    v_lshlrev_b32 v21, 2, v19
    v_xor_b32 v20, v20, v21
    v_lshl_add_u32 v9, v20, 4, v9
    v_and_b32 v21, 1, v1
    s_add_u32 m0, s80, 32768
    s_mov_b32 s81, 229376
    buffer_load_dwordx4 v4, s[44:47], s81 offen offset:0 lds
    v_lshl_add_u32 v9, v21, 3, v9
    v_xor_b32 v0, 64, v9
    s_add_u32 s52, s14, 0x7000000
    s_addc_u32 s53, s15, 0
    s_mov_b32 s5, 228352
    buffer_load_dwordx4 v4, s[48:51], s5 offen offset:1024 lds
    s_and_b32 s53, s53, 0xffff
    s_and_b32 s52, s52, 0xfe000000
    s_mov_b32 s54, 0x2000000
    s_mov_b32 s55, 0x00020000
    buffer_load_dwordx4 v58, s[44:47], s81 offen offset:2048 lds
    s_mov_b32 s56, s8
    s_and_b32 s57, s9, 0xffff
    s_mov_b32 s58, 0x188000
    s_mov_b32 s59, 0x00020000
    buffer_load_dwordx4 v58, s[48:51], s5 offen offset:3072 lds
    s_add_u32 m0, s36, 32
    s_mov_b64 exec, 1
    global_load_lds_dword v50, s[0:1]
    s_mov_b64 exec, -1
    s_mov_b32 s60, s10
    s_and_b32 s61, s11, 0xffff
    s_mov_b32 s62, 0x1c0000
    s_mov_b32 s63, 0x00020000
    s_lshl_b32 s76, s69, 11
    s_add_u32 s76, s76, 7880704
    v_lshl_add_u32 v18, v22, 4, s76
    s_lshl_b32 s76, s70, 10
    s_lshl_b32 s77, s72, 9
    s_add_u32 s76, s76, s77
    s_add_u32 s76, s76, 7946240
    v_lshl_add_u32 v19, v16, 3, s76
    v_lshl_add_u32 v19, v17, 2, v19
    s_lshl_b32 s76, s69, 1
    s_add_u32 s76, s76, s71
    s_lshl_b32 s77, s70, 1
    s_add_u32 s77, s77, s72
    s_lshl_b32 s78, s76, 8
    s_add_u32 s78, s78, 7864320
    v_mov_b32 v15, s78
    s_lshl_b32 s78, s77, 8
    s_add_u32 s78, s78, 7872512
    v_writelane_b32 v15, s78, 1
    s_mul_i32 s79, s77, 37
    s_lshr_b32 s79, s79, 8
    s_add_u32 s79, s79, s77
    s_lshl_b32 s77, s77, 1
    s_lshl_b32 s78, s76, 5
    s_add_u32 s78, s78, s79
    s_lshl_b32 s78, s78, 8
    s_add_u32 s78, s78, 7340032
    v_mov_b32 v21, s78
    s_mul_i32 s76, s76, 56
    s_add_u32 s76, s76, s77
    s_lshl_b32 s76, s76, 12
    v_and_b32 v20, 15, v1
    v_lshlrev_b32 v20, 4, v20
    v_bfe_u32 v22, v1, 4, 1
    v_lshl_add_u32 v20, v22, 10, v20
    v_lshl_add_u32 v20, v17, 8, v20
    v_add_u32 v20, s76, v20
    s_mov_b32 s75, 0
    v_mov_b32 v33, 0
    v_mov_b32 v35, 0
    v_mov_b32 v37, 0
    v_mov_b32 v39, 0
    v_mov_b32 v40, 0
    v_mov_b32 v41, 0
    v_mov_b32 v43, 0
    v_mov_b32 v44, 0
    v_mov_b32 v45, 0
    v_mov_b32 v47, 0
    v_mov_b32 v48, 0
    v_mov_b32 v49, 0
    v_lshrrev_b32 v16, 3, v1
    s_mul_i32 s76, s68, 401408
    v_mul_u32_u24 v16, 896, v16
    s_lshl_b32 s77, s74, 7
    s_add_u32 s76, s76, s77
    v_add_u32 v16, s76, v16
    v_xor_b32 v17, v1, v22
    v_and_b32 v17, 7, v17
    v_lshl_add_u32 v52, v17, 4, v16
    v_add_u32 v53, 6144, v52
    v_add_u32 v54, 12288, v52
    v_add_u32 v55, 18432, v52
    s_mov_b32 s18, 131072
    s_branch K_RTE
K_RT_R:
    ds_read_u8 v16, v11 offset:64
    s_sub_i32 s18, s18, 1
    s_max_i32 s18, s18, 0
    s_cmp_eq_u32 s18, 0
    s_cselect_b32 s19, 255, 0
    s_waitcnt lgkmcnt(0)
    v_or_b32 v16, s19, v16
    s_setpc_b64 s[20:21]
K_RT_F:
    ds_read_b32 v14, v51
    s_sub_i32 s18, s18, 1
    s_max_i32 s18, s18, 0
    s_cmp_eq_u32 s18, 0
    s_cselect_b32 s19, 255, 0
    s_waitcnt lgkmcnt(0)
    v_or_b32 v14, s19, v14
    s_setpc_b64 s[20:21]
K_RTE:
    v_mov_b32 v14, 0
    s_getpc_b64 s[20:21]
    v_cmp_gt_u32 vcc, 1, v14
    s_cbranch_vccnz K_RT_F
    s_setprio 3
    ds_read_b128 v[80:83], v5 offset:0
    ds_read_b64_tr_b16 v[88:89], v9 offset:0
    ds_read_b64_tr_b16 v[90:91], v9 offset:2048
    ds_read_b128 v[84:87], v5 offset:4096
    ds_read_b64_tr_b16 v[92:93], v9 offset:1024
    ds_read_b64_tr_b16 v[94:95], v9 offset:3072
    ds_read_b64_tr_b16 v[96:97], v0 offset:0
    ds_read_b64_tr_b16 v[98:99], v0 offset:2048
    ds_read_b64_tr_b16 v[100:101], v0 offset:1024
    ds_read_b64_tr_b16 v[102:103], v0 offset:3072
    s_waitcnt lgkmcnt(7)
    v_mfma_f32_32x32x16_bf16 v[128:143], v[88:91], v[80:83], 0
    ds_read_b128 v[104:107], v6 offset:0
    ds_read_b64_tr_b16 v[112:113], v9 offset:8192
    ds_read_b64_tr_b16 v[114:115], v9 offset:10240
    s_add_u32 m0, s80, 49152
    s_mov_b32 s81, 344064
    buffer_load_dwordx4 v4, s[44:47], s81 offen offset:0 lds
    s_waitcnt lgkmcnt(9)
    v_mfma_f32_32x32x16_bf16 v[144:159], v[88:91], v[84:87], 0
    ds_read_b128 v[108:111], v6 offset:4096
    s_waitcnt lgkmcnt(8)
    v_mfma_f32_32x32x16_bf16 v[160:175], v[92:95], v[80:83], 0
    ds_read_b64_tr_b16 v[116:117], v9 offset:9216
    ds_read_b64_tr_b16 v[118:119], v9 offset:11264
    s_mov_b32 s5, 343040
    buffer_load_dwordx4 v4, s[48:51], s5 offen offset:1024 lds
    v_mfma_f32_32x32x16_bf16 v[176:191], v[92:95], v[84:87], 0
    v_add_u32 v51, 16, v51
    ds_read_b32 v14, v51
    s_waitcnt lgkmcnt(9)
    v_mfma_f32_32x32x16_bf16 v[192:207], v[96:99], v[80:83], 0
    ds_read_b64_tr_b16 v[120:121], v0 offset:8192
    ds_read_b64_tr_b16 v[122:123], v0 offset:10240
    buffer_load_dwordx4 v58, s[44:47], s81 offen offset:2048 lds
    v_mfma_f32_32x32x16_bf16 v[208:223], v[96:99], v[84:87], 0
    ds_read_b64_tr_b16 v[124:125], v0 offset:9216
    ds_read_b64_tr_b16 v[126:127], v0 offset:11264
    v_mov_b32 v13, 1
    ds_write_b8 v12, v13 offset:64
    s_waitcnt lgkmcnt(12)
    v_mfma_f32_32x32x16_bf16 v[224:239], v[100:103], v[80:83], 0
    buffer_load_dwordx4 v58, s[48:51], s5 offen offset:3072 lds
    s_add_u32 m0, s36, 48
    s_mov_b64 exec, 1
    global_load_lds_dword v50, s[0:1]
    s_mov_b64 exec, -1
    v_mfma_f32_32x32x16_bf16 v[240:255], v[100:103], v[84:87], 0
    s_waitcnt lgkmcnt(9)
    v_mfma_f32_32x32x16_bf16 v[128:143], v[112:115], v[104:107], v[128:143]
    s_waitcnt lgkmcnt(5)
    s_getpc_b64 s[20:21]
    v_cmp_gt_u32 vcc, 1, v14
    s_cbranch_vccnz K_RT_F
    ds_read_b128 v[80:83], v7 offset:0
    ds_read_b64_tr_b16 v[88:89], v9 offset:16384
    ds_read_b64_tr_b16 v[90:91], v9 offset:18432
    v_mfma_f32_32x32x16_bf16 v[144:159], v[112:115], v[108:111], v[144:159]
    ds_read_b128 v[84:87], v7 offset:4096
    s_add_u32 m0, s80, 81920
    s_movk_i32 s6, 256
    buffer_load_dwordx4 v2, s[40:43], s6 offen offset:0 lds
    v_mfma_f32_32x32x16_bf16 v[160:175], v[116:119], v[104:107], v[160:175]
    ds_read_b64_tr_b16 v[92:93], v9 offset:17408
    ds_read_b64_tr_b16 v[94:95], v9 offset:19456
    v_mfma_f32_32x32x16_bf16 v[176:191], v[116:119], v[108:111], v[176:191]
    buffer_load_dwordx4 v3, s[40:43], s6 offen offset:1024 lds
    s_waitcnt lgkmcnt(9)
    v_mfma_f32_32x32x16_bf16 v[192:207], v[120:123], v[104:107], v[192:207]
    ds_read_b64_tr_b16 v[96:97], v0 offset:16384
    ds_read_b64_tr_b16 v[98:99], v0 offset:18432
    v_mfma_f32_32x32x16_bf16 v[208:223], v[120:123], v[108:111], v[208:223]
    ds_read_b64_tr_b16 v[100:101], v0 offset:17408
    ds_read_b64_tr_b16 v[102:103], v0 offset:19456
    buffer_load_dwordx4 v56, s[40:43], s6 offen offset:2048 lds
    s_waitcnt lgkmcnt(11)
    v_mfma_f32_32x32x16_bf16 v[224:239], v[124:127], v[104:107], v[224:239]
    v_mfma_f32_32x32x16_bf16 v[240:255], v[124:127], v[108:111], v[240:255]
    buffer_load_dwordx4 v57, s[40:43], s6 offen offset:3072 lds
    ds_read_u8 v16, v11 offset:64
    s_waitcnt lgkmcnt(8)
    v_mfma_f32_32x32x16_bf16 v[128:143], v[88:91], v[80:83], v[128:143]
    ds_read_b128 v[104:107], v8 offset:0
    ds_read_b64_tr_b16 v[112:113], v9 offset:24576
    ds_read_b64_tr_b16 v[114:115], v9 offset:26624
    s_waitcnt lgkmcnt(10)
    v_mfma_f32_32x32x16_bf16 v[144:159], v[88:91], v[84:87], v[144:159]
    ds_read_b128 v[108:111], v8 offset:4096
    s_waitcnt lgkmcnt(9)
    v_mfma_f32_32x32x16_bf16 v[160:175], v[92:95], v[80:83], v[160:175]
    ds_read_b64_tr_b16 v[116:117], v9 offset:25600
    ds_read_b64_tr_b16 v[118:119], v9 offset:27648
    v_mfma_f32_32x32x16_bf16 v[176:191], v[92:95], v[84:87], v[176:191]
    s_waitcnt lgkmcnt(6)
    s_getpc_b64 s[20:21]
    v_cmp_gt_u32 vcc, 1, v16
    s_cbranch_vccnz K_RT_R
    v_add_u32 v51, 16, v51
    ds_read_b32 v14, v51
    v_mfma_f32_32x32x16_bf16 v[192:207], v[96:99], v[80:83], v[192:207]
    ds_read_b64_tr_b16 v[120:121], v0 offset:24576
    ds_read_b64_tr_b16 v[122:123], v0 offset:26624
    s_add_u32 m0, s80, 0
    s_mov_b32 s81, 458752
    buffer_load_dwordx4 v4, s[44:47], s81 offen offset:0 lds
    v_mfma_f32_32x32x16_bf16 v[208:223], v[96:99], v[84:87], v[208:223]
    ds_read_b64_tr_b16 v[124:125], v0 offset:25600
    ds_read_b64_tr_b16 v[126:127], v0 offset:27648
    v_mov_b32 v13, 2
    ds_write_b8 v12, v13 offset:64
    v_mfma_f32_32x32x16_bf16 v[224:239], v[100:103], v[80:83], v[224:239]
    s_mov_b32 s5, 457728
    buffer_load_dwordx4 v4, s[48:51], s5 offen offset:1024 lds
    v_mfma_f32_32x32x16_bf16 v[240:255], v[100:103], v[84:87], v[240:255]
    s_waitcnt lgkmcnt(9)
    v_mfma_f32_32x32x16_bf16 v[128:143], v[112:115], v[104:107], v[128:143]
    s_waitcnt lgkmcnt(5)
    s_getpc_b64 s[20:21]
    v_cmp_gt_u32 vcc, 1, v14
    s_cbranch_vccnz K_RT_F
    ds_read_b128 v[80:83], v5 offset:50176
    ds_read_b64_tr_b16 v[88:89], v9 offset:32768
    ds_read_b64_tr_b16 v[90:91], v9 offset:34816
    v_mfma_f32_32x32x16_bf16 v[144:159], v[112:115], v[108:111], v[144:159]
    ds_read_b128 v[84:87], v5 offset:54272
    buffer_load_dwordx4 v58, s[44:47], s81 offen offset:2048 lds
    v_mfma_f32_32x32x16_bf16 v[160:175], v[116:119], v[104:107], v[160:175]
    ds_read_b64_tr_b16 v[92:93], v9 offset:33792
    ds_read_b64_tr_b16 v[94:95], v9 offset:35840
    v_mfma_f32_32x32x16_bf16 v[176:191], v[116:119], v[108:111], v[176:191]
    buffer_load_dwordx4 v58, s[48:51], s5 offen offset:3072 lds
    s_add_u32 m0, s36, 64
    s_mov_b64 exec, 1
    global_load_lds_dword v50, s[0:1]
    s_mov_b64 exec, -1
    s_waitcnt lgkmcnt(9)
    v_mfma_f32_32x32x16_bf16 v[192:207], v[120:123], v[104:107], v[192:207]
    ds_read_b64_tr_b16 v[96:97], v0 offset:32768
    ds_read_b64_tr_b16 v[98:99], v0 offset:34816
    v_mfma_f32_32x32x16_bf16 v[208:223], v[120:123], v[108:111], v[208:223]
    ds_read_b64_tr_b16 v[100:101], v0 offset:33792
    ds_read_b64_tr_b16 v[102:103], v0 offset:35840
    s_waitcnt lgkmcnt(11)
    v_mfma_f32_32x32x16_bf16 v[224:239], v[124:127], v[104:107], v[224:239]
    v_mfma_f32_32x32x16_bf16 v[240:255], v[124:127], v[108:111], v[240:255]
    ds_read_u8 v16, v11 offset:64
    s_waitcnt lgkmcnt(8)
    v_mfma_f32_32x32x16_bf16 v[128:143], v[88:91], v[80:83], v[128:143]
    ds_read_b128 v[104:107], v6 offset:50176
    ds_read_b64_tr_b16 v[112:113], v9 offset:40960
    ds_read_b64_tr_b16 v[114:115], v9 offset:43008
    s_waitcnt lgkmcnt(10)
    v_mfma_f32_32x32x16_bf16 v[144:159], v[88:91], v[84:87], v[144:159]
    ds_read_b128 v[108:111], v6 offset:54272
    s_waitcnt lgkmcnt(9)
    v_mfma_f32_32x32x16_bf16 v[160:175], v[92:95], v[80:83], v[160:175]
    ds_read_b64_tr_b16 v[116:117], v9 offset:41984
    ds_read_b64_tr_b16 v[118:119], v9 offset:44032
    v_mfma_f32_32x32x16_bf16 v[176:191], v[92:95], v[84:87], v[176:191]
    s_waitcnt lgkmcnt(6)
    s_getpc_b64 s[20:21]
    v_cmp_gt_u32 vcc, 2, v16
    s_cbranch_vccnz K_RT_R
    v_add_u32 v51, 16, v51
    ds_read_b32 v14, v51
    v_mfma_f32_32x32x16_bf16 v[192:207], v[96:99], v[80:83], v[192:207]
    ds_read_b64_tr_b16 v[120:121], v0 offset:40960
    ds_read_b64_tr_b16 v[122:123], v0 offset:43008
    s_add_u32 m0, s80, 16384
    s_mov_b32 s81, 573440
    buffer_load_dwordx4 v4, s[44:47], s81 offen offset:0 lds
    v_mfma_f32_32x32x16_bf16 v[208:223], v[96:99], v[84:87], v[208:223]
    ds_read_b64_tr_b16 v[124:125], v0 offset:41984
    ds_read_b64_tr_b16 v[126:127], v0 offset:44032
    v_mov_b32 v13, 3
    ds_write_b8 v12, v13 offset:64
    v_mfma_f32_32x32x16_bf16 v[224:239], v[100:103], v[80:83], v[224:239]
    s_mov_b32 s5, 572416
    buffer_load_dwordx4 v4, s[48:51], s5 offen offset:1024 lds
    v_mfma_f32_32x32x16_bf16 v[240:255], v[100:103], v[84:87], v[240:255]
    s_waitcnt lgkmcnt(9)
    v_mfma_f32_32x32x16_bf16 v[128:143], v[112:115], v[104:107], v[128:143]
    s_waitcnt lgkmcnt(5)
    s_getpc_b64 s[20:21]
    v_cmp_gt_u32 vcc, 1, v14
    s_cbranch_vccnz K_RT_F
    ds_read_b128 v[80:83], v7 offset:50176
    ds_read_b64_tr_b16 v[88:89], v9 offset:49152
    ds_read_b64_tr_b16 v[90:91], v9 offset:51200
    v_mfma_f32_32x32x16_bf16 v[144:159], v[112:115], v[108:111], v[144:159]
    ds_read_b128 v[84:87], v7 offset:54272
    buffer_load_dwordx4 v58, s[44:47], s81 offen offset:2048 lds
    v_mfma_f32_32x32x16_bf16 v[160:175], v[116:119], v[104:107], v[160:175]
    ds_read_b64_tr_b16 v[92:93], v9 offset:50176
    ds_read_b64_tr_b16 v[94:95], v9 offset:52224
    v_mfma_f32_32x32x16_bf16 v[176:191], v[116:119], v[108:111], v[176:191]
    buffer_load_dwordx4 v58, s[48:51], s5 offen offset:3072 lds
    s_add_u32 m0, s36, 80
    s_mov_b64 exec, 1
    global_load_lds_dword v50, s[0:1]
    s_mov_b64 exec, -1
    s_waitcnt lgkmcnt(9)
    v_mfma_f32_32x32x16_bf16 v[192:207], v[120:123], v[104:107], v[192:207]
    ds_read_b64_tr_b16 v[96:97], v0 offset:49152
    ds_read_b64_tr_b16 v[98:99], v0 offset:51200
    v_mfma_f32_32x32x16_bf16 v[208:223], v[120:123], v[108:111], v[208:223]
    ds_read_b64_tr_b16 v[100:101], v0 offset:50176
    ds_read_b64_tr_b16 v[102:103], v0 offset:52224
    s_add_u32 m0, s80, 65536
    s_movk_i32 s6, 384
    buffer_load_dwordx4 v2, s[40:43], s6 offen offset:0 lds
    s_waitcnt lgkmcnt(11)
    v_mfma_f32_32x32x16_bf16 v[224:239], v[124:127], v[104:107], v[224:239]
    v_mfma_f32_32x32x16_bf16 v[240:255], v[124:127], v[108:111], v[240:255]
    buffer_load_dwordx4 v3, s[40:43], s6 offen offset:1024 lds
    ds_read_u8 v16, v11 offset:64
    s_waitcnt lgkmcnt(8)
    v_mfma_f32_32x32x16_bf16 v[128:143], v[88:91], v[80:83], v[128:143]
    ds_read_b128 v[104:107], v8 offset:50176
    ds_read_b64_tr_b16 v[112:113], v9 offset:57344
    ds_read_b64_tr_b16 v[114:115], v9 offset:59392
    s_waitcnt lgkmcnt(10)
    v_mfma_f32_32x32x16_bf16 v[144:159], v[88:91], v[84:87], v[144:159]
    ds_read_b128 v[108:111], v8 offset:54272
    s_waitcnt lgkmcnt(9)
    v_mfma_f32_32x32x16_bf16 v[160:175], v[92:95], v[80:83], v[160:175]
    ds_read_b64_tr_b16 v[116:117], v9 offset:58368
    ds_read_b64_tr_b16 v[118:119], v9 offset:60416
    v_mfma_f32_32x32x16_bf16 v[176:191], v[92:95], v[84:87], v[176:191]
    s_waitcnt lgkmcnt(6)
    s_getpc_b64 s[20:21]
    v_cmp_gt_u32 vcc, 3, v16
    s_cbranch_vccnz K_RT_R
    v_add_u32 v51, 16, v51
    ds_read_b32 v14, v51
    v_mfma_f32_32x32x16_bf16 v[192:207], v[96:99], v[80:83], v[192:207]
    ds_read_b64_tr_b16 v[120:121], v0 offset:57344
    ds_read_b64_tr_b16 v[122:123], v0 offset:59392
    buffer_load_dwordx4 v56, s[40:43], s6 offen offset:2048 lds
    v_mfma_f32_32x32x16_bf16 v[208:223], v[96:99], v[84:87], v[208:223]
    ds_read_b64_tr_b16 v[124:125], v0 offset:58368
    ds_read_b64_tr_b16 v[126:127], v0 offset:60416
    v_mov_b32 v13, 4
    ds_write_b8 v12, v13 offset:64
    v_mfma_f32_32x32x16_bf16 v[224:239], v[100:103], v[80:83], v[224:239]
    buffer_load_dwordx4 v57, s[40:43], s6 offen offset:3072 lds
    v_mfma_f32_32x32x16_bf16 v[240:255], v[100:103], v[84:87], v[240:255]
    s_waitcnt lgkmcnt(9)
    v_mfma_f32_32x32x16_bf16 v[128:143], v[112:115], v[104:107], v[128:143]
    s_waitcnt lgkmcnt(5)
    s_getpc_b64 s[20:21]
    v_cmp_gt_u32 vcc, 1, v14
    s_cbranch_vccnz K_RT_F
    ds_read_b128 v[80:83], v5 offset:16384
    ds_read_b64_tr_b16 v[88:89], v9 offset:0
    ds_read_b64_tr_b16 v[90:91], v9 offset:2048
    v_mfma_f32_32x32x16_bf16 v[144:159], v[112:115], v[108:111], v[144:159]
    ds_read_b128 v[84:87], v5 offset:20480
    s_add_u32 m0, s80, 32768
    s_mov_b32 s81, 688128
    buffer_load_dwordx4 v4, s[44:47], s81 offen offset:0 lds
    v_mfma_f32_32x32x16_bf16 v[160:175], v[116:119], v[104:107], v[160:175]
    ds_read_b64_tr_b16 v[92:93], v9 offset:1024
    ds_read_b64_tr_b16 v[94:95], v9 offset:3072
    v_mfma_f32_32x32x16_bf16 v[176:191], v[116:119], v[108:111], v[176:191]
    s_mov_b32 s5, 687104
    buffer_load_dwordx4 v4, s[48:51], s5 offen offset:1024 lds
    s_waitcnt lgkmcnt(9)
    v_mfma_f32_32x32x16_bf16 v[192:207], v[120:123], v[104:107], v[192:207]
    ds_read_b64_tr_b16 v[96:97], v0 offset:0
    ds_read_b64_tr_b16 v[98:99], v0 offset:2048
    v_mfma_f32_32x32x16_bf16 v[208:223], v[120:123], v[108:111], v[208:223]
    ds_read_b64_tr_b16 v[100:101], v0 offset:1024
    ds_read_b64_tr_b16 v[102:103], v0 offset:3072
    buffer_load_dwordx4 v58, s[44:47], s81 offen offset:2048 lds
    s_waitcnt lgkmcnt(11)
    v_mfma_f32_32x32x16_bf16 v[224:239], v[124:127], v[104:107], v[224:239]
    v_mfma_f32_32x32x16_bf16 v[240:255], v[124:127], v[108:111], v[240:255]
    buffer_load_dwordx4 v58, s[48:51], s5 offen offset:3072 lds
    s_add_u32 m0, s36, 96
    s_mov_b64 exec, 1
    global_load_lds_dword v50, s[0:1]
    s_mov_b64 exec, -1
    ds_read_u8 v16, v11 offset:64
    s_waitcnt lgkmcnt(8)
    v_mfma_f32_32x32x16_bf16 v[128:143], v[88:91], v[80:83], v[128:143]
    ds_read_b128 v[104:107], v6 offset:16384
    ds_read_b64_tr_b16 v[112:113], v9 offset:8192
    ds_read_b64_tr_b16 v[114:115], v9 offset:10240
    s_waitcnt lgkmcnt(10)
    v_mfma_f32_32x32x16_bf16 v[144:159], v[88:91], v[84:87], v[144:159]
    ds_read_b128 v[108:111], v6 offset:20480
    s_waitcnt lgkmcnt(9)
    v_mfma_f32_32x32x16_bf16 v[160:175], v[92:95], v[80:83], v[160:175]
    ds_read_b64_tr_b16 v[116:117], v9 offset:9216
    ds_read_b64_tr_b16 v[118:119], v9 offset:11264
    v_mfma_f32_32x32x16_bf16 v[176:191], v[92:95], v[84:87], v[176:191]
    s_waitcnt lgkmcnt(6)
    s_getpc_b64 s[20:21]
    v_cmp_gt_u32 vcc, 4, v16
    s_cbranch_vccnz K_RT_R
    v_add_u32 v51, 16, v51
    ds_read_b32 v14, v51
    v_mfma_f32_32x32x16_bf16 v[192:207], v[96:99], v[80:83], v[192:207]
    ds_read_b64_tr_b16 v[120:121], v0 offset:8192
    ds_read_b64_tr_b16 v[122:123], v0 offset:10240
    s_add_u32 m0, s80, 49152
    s_mov_b32 s81, 802816
    buffer_load_dwordx4 v4, s[44:47], s81 offen offset:0 lds
    v_mfma_f32_32x32x16_bf16 v[208:223], v[96:99], v[84:87], v[208:223]
    ds_read_b64_tr_b16 v[124:125], v0 offset:9216
    ds_read_b64_tr_b16 v[126:127], v0 offset:11264
    v_mov_b32 v13, 5
    ds_write_b8 v12, v13 offset:64
    v_mfma_f32_32x32x16_bf16 v[224:239], v[100:103], v[80:83], v[224:239]
    s_mov_b32 s5, 801792
    buffer_load_dwordx4 v4, s[48:51], s5 offen offset:1024 lds
    v_mfma_f32_32x32x16_bf16 v[240:255], v[100:103], v[84:87], v[240:255]
    s_waitcnt lgkmcnt(9)
    v_mfma_f32_32x32x16_bf16 v[128:143], v[112:115], v[104:107], v[128:143]
    s_waitcnt lgkmcnt(5)
    s_getpc_b64 s[20:21]
    v_cmp_gt_u32 vcc, 1, v14
    s_cbranch_vccnz K_RT_F
    ds_read_b128 v[80:83], v7 offset:16384
    ds_read_b64_tr_b16 v[88:89], v9 offset:16384
    ds_read_b64_tr_b16 v[90:91], v9 offset:18432
    v_mfma_f32_32x32x16_bf16 v[144:159], v[112:115], v[108:111], v[144:159]
    ds_read_b128 v[84:87], v7 offset:20480
    buffer_load_dwordx4 v58, s[44:47], s81 offen offset:2048 lds
    v_mfma_f32_32x32x16_bf16 v[160:175], v[116:119], v[104:107], v[160:175]
    ds_read_b64_tr_b16 v[92:93], v9 offset:17408
    ds_read_b64_tr_b16 v[94:95], v9 offset:19456
    v_mfma_f32_32x32x16_bf16 v[176:191], v[116:119], v[108:111], v[176:191]
    buffer_load_dwordx4 v58, s[48:51], s5 offen offset:3072 lds
    s_add_u32 m0, s36, 112
    s_mov_b64 exec, 1
    global_load_lds_dword v50, s[0:1]
    s_mov_b64 exec, -1
    s_waitcnt lgkmcnt(9)
    v_mfma_f32_32x32x16_bf16 v[192:207], v[120:123], v[104:107], v[192:207]
    ds_read_b64_tr_b16 v[96:97], v0 offset:16384
    ds_read_b64_tr_b16 v[98:99], v0 offset:18432
    v_mfma_f32_32x32x16_bf16 v[208:223], v[120:123], v[108:111], v[208:223]
    ds_read_b64_tr_b16 v[100:101], v0 offset:17408
    ds_read_b64_tr_b16 v[102:103], v0 offset:19456
    s_add_u32 m0, s80, 115712
    s_movk_i32 s6, 512
    buffer_load_dwordx4 v2, s[40:43], s6 offen offset:0 lds
    s_waitcnt lgkmcnt(11)
    v_mfma_f32_32x32x16_bf16 v[224:239], v[124:127], v[104:107], v[224:239]
    v_mfma_f32_32x32x16_bf16 v[240:255], v[124:127], v[108:111], v[240:255]
    buffer_load_dwordx4 v3, s[40:43], s6 offen offset:1024 lds
    ds_read_u8 v16, v11 offset:64
    s_waitcnt lgkmcnt(8)
    v_mfma_f32_32x32x16_bf16 v[128:143], v[88:91], v[80:83], v[128:143]
    ds_read_b128 v[104:107], v8 offset:16384
    ds_read_b64_tr_b16 v[112:113], v9 offset:24576
    ds_read_b64_tr_b16 v[114:115], v9 offset:26624
    s_waitcnt lgkmcnt(10)
    v_mfma_f32_32x32x16_bf16 v[144:159], v[88:91], v[84:87], v[144:159]
    ds_read_b128 v[108:111], v8 offset:20480
    s_waitcnt lgkmcnt(9)
    v_mfma_f32_32x32x16_bf16 v[160:175], v[92:95], v[80:83], v[160:175]
    ds_read_b64_tr_b16 v[116:117], v9 offset:25600
    ds_read_b64_tr_b16 v[118:119], v9 offset:27648
    v_mfma_f32_32x32x16_bf16 v[176:191], v[92:95], v[84:87], v[176:191]
    s_waitcnt lgkmcnt(6)
    s_getpc_b64 s[20:21]
    v_cmp_gt_u32 vcc, 5, v16
    s_cbranch_vccnz K_RT_R
    v_add_u32 v51, 16, v51
    ds_read_b32 v14, v51
    v_mfma_f32_32x32x16_bf16 v[192:207], v[96:99], v[80:83], v[192:207]
    ds_read_b64_tr_b16 v[120:121], v0 offset:24576
    ds_read_b64_tr_b16 v[122:123], v0 offset:26624
    buffer_load_dwordx4 v56, s[40:43], s6 offen offset:2048 lds
    v_mfma_f32_32x32x16_bf16 v[208:223], v[96:99], v[84:87], v[208:223]
    ds_read_b64_tr_b16 v[124:125], v0 offset:25600
    ds_read_b64_tr_b16 v[126:127], v0 offset:27648
    v_mov_b32 v13, 6
    ds_write_b8 v12, v13 offset:64
    v_mfma_f32_32x32x16_bf16 v[224:239], v[100:103], v[80:83], v[224:239]
    buffer_load_dwordx4 v57, s[40:43], s6 offen offset:3072 lds
    v_mfma_f32_32x32x16_bf16 v[240:255], v[100:103], v[84:87], v[240:255]
    s_waitcnt lgkmcnt(9)
    v_mfma_f32_32x32x16_bf16 v[128:143], v[112:115], v[104:107], v[128:143]
    s_waitcnt lgkmcnt(5)
    s_getpc_b64 s[20:21]
    v_cmp_gt_u32 vcc, 1, v14
    s_cbranch_vccnz K_RT_F
    ds_read_b128 v[80:83], v5 offset:0
    ds_read_b64_tr_b16 v[88:89], v9 offset:32768
    ds_read_b64_tr_b16 v[90:91], v9 offset:34816
    v_mfma_f32_32x32x16_bf16 v[144:159], v[112:115], v[108:111], v[144:159]
    ds_read_b128 v[84:87], v5 offset:4096
    s_add_u32 m0, s80, 0
    s_mov_b32 s81, 917504
    buffer_load_dwordx4 v4, s[44:47], s81 offen offset:0 lds
    v_mfma_f32_32x32x16_bf16 v[160:175], v[116:119], v[104:107], v[160:175]
    ds_read_b64_tr_b16 v[92:93], v9 offset:33792
    ds_read_b64_tr_b16 v[94:95], v9 offset:35840
    v_mfma_f32_32x32x16_bf16 v[176:191], v[116:119], v[108:111], v[176:191]
    s_mov_b32 s5, 916480
    buffer_load_dwordx4 v4, s[48:51], s5 offen offset:1024 lds
    s_waitcnt lgkmcnt(9)
    v_mfma_f32_32x32x16_bf16 v[192:207], v[120:123], v[104:107], v[192:207]
    ds_read_b64_tr_b16 v[96:97], v0 offset:32768
    ds_read_b64_tr_b16 v[98:99], v0 offset:34816
    v_mfma_f32_32x32x16_bf16 v[208:223], v[120:123], v[108:111], v[208:223]
    ds_read_b64_tr_b16 v[100:101], v0 offset:33792
    ds_read_b64_tr_b16 v[102:103], v0 offset:35840
    buffer_load_dwordx4 v58, s[44:47], s81 offen offset:2048 lds
    s_waitcnt lgkmcnt(11)
    v_mfma_f32_32x32x16_bf16 v[224:239], v[124:127], v[104:107], v[224:239]
    v_mfma_f32_32x32x16_bf16 v[240:255], v[124:127], v[108:111], v[240:255]
    buffer_load_dwordx4 v58, s[48:51], s5 offen offset:3072 lds
    s_add_u32 m0, s36, 128
    s_mov_b64 exec, 1
    global_load_lds_dword v50, s[0:1]
    s_mov_b64 exec, -1
    ds_read_u8 v16, v11 offset:64
    s_waitcnt lgkmcnt(8)
    v_mfma_f32_32x32x16_bf16 v[128:143], v[88:91], v[80:83], v[128:143]
    ds_read_b128 v[104:107], v6 offset:0
    ds_read_b64_tr_b16 v[112:113], v9 offset:40960
    ds_read_b64_tr_b16 v[114:115], v9 offset:43008
    s_waitcnt lgkmcnt(10)
    v_mfma_f32_32x32x16_bf16 v[144:159], v[88:91], v[84:87], v[144:159]
    ds_read_b128 v[108:111], v6 offset:4096
    s_waitcnt lgkmcnt(9)
    v_mfma_f32_32x32x16_bf16 v[160:175], v[92:95], v[80:83], v[160:175]
    ds_read_b64_tr_b16 v[116:117], v9 offset:41984
    ds_read_b64_tr_b16 v[118:119], v9 offset:44032
    v_mfma_f32_32x32x16_bf16 v[176:191], v[92:95], v[84:87], v[176:191]
    s_waitcnt lgkmcnt(6)
    s_getpc_b64 s[20:21]
    v_cmp_gt_u32 vcc, 6, v16
    s_cbranch_vccnz K_RT_R
    v_add_u32 v51, 16, v51
    ds_read_b32 v14, v51
    v_mfma_f32_32x32x16_bf16 v[192:207], v[96:99], v[80:83], v[192:207]
    ds_read_b64_tr_b16 v[120:121], v0 offset:40960
    ds_read_b64_tr_b16 v[122:123], v0 offset:43008
    s_add_u32 m0, s80, 16384
    s_mov_b32 s81, 1032192
    buffer_load_dwordx4 v4, s[44:47], s81 offen offset:0 lds
    v_mfma_f32_32x32x16_bf16 v[208:223], v[96:99], v[84:87], v[208:223]
    ds_read_b64_tr_b16 v[124:125], v0 offset:41984
    ds_read_b64_tr_b16 v[126:127], v0 offset:44032
    v_mov_b32 v13, 7
    ds_write_b8 v12, v13 offset:64
    v_mfma_f32_32x32x16_bf16 v[224:239], v[100:103], v[80:83], v[224:239]
    s_mov_b32 s5, 1031168
    buffer_load_dwordx4 v4, s[48:51], s5 offen offset:1024 lds
    v_mfma_f32_32x32x16_bf16 v[240:255], v[100:103], v[84:87], v[240:255]
    s_waitcnt lgkmcnt(9)
    v_mfma_f32_32x32x16_bf16 v[128:143], v[112:115], v[104:107], v[128:143]
    s_waitcnt lgkmcnt(5)
    s_getpc_b64 s[20:21]
    v_cmp_gt_u32 vcc, 1, v14
    s_cbranch_vccnz K_RT_F
    ds_read_b128 v[80:83], v7 offset:0
    ds_read_b64_tr_b16 v[88:89], v9 offset:49152
    ds_read_b64_tr_b16 v[90:91], v9 offset:51200
    v_mfma_f32_32x32x16_bf16 v[144:159], v[112:115], v[108:111], v[144:159]
    ds_read_b128 v[84:87], v7 offset:4096
    buffer_load_dwordx4 v58, s[44:47], s81 offen offset:2048 lds
    v_mfma_f32_32x32x16_bf16 v[160:175], v[116:119], v[104:107], v[160:175]
    ds_read_b64_tr_b16 v[92:93], v9 offset:50176
    ds_read_b64_tr_b16 v[94:95], v9 offset:52224
    v_mfma_f32_32x32x16_bf16 v[176:191], v[116:119], v[108:111], v[176:191]
    buffer_load_dwordx4 v58, s[48:51], s5 offen offset:3072 lds
    s_add_u32 m0, s36, 144
    s_mov_b64 exec, 1
    global_load_lds_dword v50, s[0:1]
    s_mov_b64 exec, -1
    s_waitcnt lgkmcnt(9)
    v_mfma_f32_32x32x16_bf16 v[192:207], v[120:123], v[104:107], v[192:207]
    ds_read_b64_tr_b16 v[96:97], v0 offset:49152
    ds_read_b64_tr_b16 v[98:99], v0 offset:51200
    v_mfma_f32_32x32x16_bf16 v[208:223], v[120:123], v[108:111], v[208:223]
    ds_read_b64_tr_b16 v[100:101], v0 offset:50176
    ds_read_b64_tr_b16 v[102:103], v0 offset:52224
    s_add_u32 m0, s80, 81920
    s_movk_i32 s6, 640
    buffer_load_dwordx4 v2, s[40:43], s6 offen offset:0 lds
    s_waitcnt lgkmcnt(11)
    v_mfma_f32_32x32x16_bf16 v[224:239], v[124:127], v[104:107], v[224:239]
    v_mfma_f32_32x32x16_bf16 v[240:255], v[124:127], v[108:111], v[240:255]
    buffer_load_dwordx4 v3, s[40:43], s6 offen offset:1024 lds
    ds_read_u8 v16, v11 offset:64
    s_waitcnt lgkmcnt(8)
    v_mfma_f32_32x32x16_bf16 v[128:143], v[88:91], v[80:83], v[128:143]
    ds_read_b128 v[104:107], v8 offset:0
    ds_read_b64_tr_b16 v[112:113], v9 offset:57344
    ds_read_b64_tr_b16 v[114:115], v9 offset:59392
    s_waitcnt lgkmcnt(10)
    v_mfma_f32_32x32x16_bf16 v[144:159], v[88:91], v[84:87], v[144:159]
    ds_read_b128 v[108:111], v8 offset:4096
    s_waitcnt lgkmcnt(9)
    v_mfma_f32_32x32x16_bf16 v[160:175], v[92:95], v[80:83], v[160:175]
    ds_read_b64_tr_b16 v[116:117], v9 offset:58368
    ds_read_b64_tr_b16 v[118:119], v9 offset:60416
    v_mfma_f32_32x32x16_bf16 v[176:191], v[92:95], v[84:87], v[176:191]
    s_waitcnt lgkmcnt(6)
    s_getpc_b64 s[20:21]
    v_cmp_gt_u32 vcc, 7, v16
    s_cbranch_vccnz K_RT_R
    v_add_u32 v51, 16, v51
    ds_read_b32 v14, v51
    v_mfma_f32_32x32x16_bf16 v[192:207], v[96:99], v[80:83], v[192:207]
    ds_read_b64_tr_b16 v[120:121], v0 offset:57344
    ds_read_b64_tr_b16 v[122:123], v0 offset:59392
    buffer_load_dwordx4 v56, s[40:43], s6 offen offset:2048 lds
    v_mfma_f32_32x32x16_bf16 v[208:223], v[96:99], v[84:87], v[208:223]
    ds_read_b64_tr_b16 v[124:125], v0 offset:58368
    ds_read_b64_tr_b16 v[126:127], v0 offset:60416
    v_mov_b32 v13, 8
    ds_write_b8 v12, v13 offset:64
    v_mfma_f32_32x32x16_bf16 v[224:239], v[100:103], v[80:83], v[224:239]
    buffer_load_dwordx4 v57, s[40:43], s6 offen offset:3072 lds
    v_mfma_f32_32x32x16_bf16 v[240:255], v[100:103], v[84:87], v[240:255]
    s_waitcnt lgkmcnt(9)
    v_mfma_f32_32x32x16_bf16 v[128:143], v[112:115], v[104:107], v[128:143]
    s_waitcnt lgkmcnt(5)
    s_getpc_b64 s[20:21]
    v_cmp_gt_u32 vcc, 1, v14
    s_cbranch_vccnz K_RT_F
    ds_read_b128 v[80:83], v5 offset:50176
    ds_read_b64_tr_b16 v[88:89], v9 offset:0
    ds_read_b64_tr_b16 v[90:91], v9 offset:2048
    v_mfma_f32_32x32x16_bf16 v[144:159], v[112:115], v[108:111], v[144:159]
    ds_read_b128 v[84:87], v5 offset:54272
    s_add_u32 m0, s80, 32768
    s_mov_b32 s81, 1146880
    buffer_load_dwordx4 v4, s[44:47], s81 offen offset:0 lds
    v_mfma_f32_32x32x16_bf16 v[160:175], v[116:119], v[104:107], v[160:175]
    ds_read_b64_tr_b16 v[92:93], v9 offset:1024
    ds_read_b64_tr_b16 v[94:95], v9 offset:3072
    v_mfma_f32_32x32x16_bf16 v[176:191], v[116:119], v[108:111], v[176:191]
    s_mov_b32 s5, 1145856
    buffer_load_dwordx4 v4, s[48:51], s5 offen offset:1024 lds
    s_waitcnt lgkmcnt(9)
    v_mfma_f32_32x32x16_bf16 v[192:207], v[120:123], v[104:107], v[192:207]
    ds_read_b64_tr_b16 v[96:97], v0 offset:0
    ds_read_b64_tr_b16 v[98:99], v0 offset:2048
    v_mfma_f32_32x32x16_bf16 v[208:223], v[120:123], v[108:111], v[208:223]
    ds_read_b64_tr_b16 v[100:101], v0 offset:1024
    ds_read_b64_tr_b16 v[102:103], v0 offset:3072
    buffer_load_dwordx4 v58, s[44:47], s81 offen offset:2048 lds
    s_waitcnt lgkmcnt(11)
    v_mfma_f32_32x32x16_bf16 v[224:239], v[124:127], v[104:107], v[224:239]
    v_mfma_f32_32x32x16_bf16 v[240:255], v[124:127], v[108:111], v[240:255]
    buffer_load_dwordx4 v58, s[48:51], s5 offen offset:3072 lds
    s_add_u32 m0, s36, 160
    s_mov_b64 exec, 1
    global_load_lds_dword v50, s[0:1]
    s_mov_b64 exec, -1
    ds_read_u8 v16, v11 offset:64
    s_waitcnt lgkmcnt(8)
    v_mfma_f32_32x32x16_bf16 v[128:143], v[88:91], v[80:83], v[128:143]
    ds_read_b128 v[104:107], v6 offset:50176
    ds_read_b64_tr_b16 v[112:113], v9 offset:8192
    ds_read_b64_tr_b16 v[114:115], v9 offset:10240
    s_waitcnt lgkmcnt(10)
    v_mfma_f32_32x32x16_bf16 v[144:159], v[88:91], v[84:87], v[144:159]
    ds_read_b128 v[108:111], v6 offset:54272
    s_waitcnt lgkmcnt(9)
    v_mfma_f32_32x32x16_bf16 v[160:175], v[92:95], v[80:83], v[160:175]
    ds_read_b64_tr_b16 v[116:117], v9 offset:9216
    ds_read_b64_tr_b16 v[118:119], v9 offset:11264
    v_mfma_f32_32x32x16_bf16 v[176:191], v[92:95], v[84:87], v[176:191]
    s_waitcnt lgkmcnt(6)
    s_getpc_b64 s[20:21]
    v_cmp_gt_u32 vcc, 8, v16
    s_cbranch_vccnz K_RT_R
    v_add_u32 v51, 16, v51
    ds_read_b32 v14, v51
    v_mfma_f32_32x32x16_bf16 v[192:207], v[96:99], v[80:83], v[192:207]
    ds_read_b64_tr_b16 v[120:121], v0 offset:8192
    ds_read_b64_tr_b16 v[122:123], v0 offset:10240
    s_add_u32 m0, s80, 49152
    s_mov_b32 s81, 1261568
    buffer_load_dwordx4 v4, s[44:47], s81 offen offset:0 lds
    v_mfma_f32_32x32x16_bf16 v[208:223], v[96:99], v[84:87], v[208:223]
    ds_read_b64_tr_b16 v[124:125], v0 offset:9216
    ds_read_b64_tr_b16 v[126:127], v0 offset:11264
    ds_read_b64 v[22:23], v10 offset:8
    v_mov_b32 v13, 9
    ds_write_b8 v12, v13 offset:64
    v_mfma_f32_32x32x16_bf16 v[224:239], v[100:103], v[80:83], v[224:239]
    s_mov_b32 s5, 1260544
    buffer_load_dwordx4 v4, s[48:51], s5 offen offset:1024 lds
    v_mfma_f32_32x32x16_bf16 v[240:255], v[100:103], v[84:87], v[240:255]
    s_waitcnt lgkmcnt(10)
    v_mfma_f32_32x32x16_bf16 v[128:143], v[112:115], v[104:107], v[128:143]
    s_waitcnt lgkmcnt(6)
    s_getpc_b64 s[20:21]
    v_cmp_gt_u32 vcc, 1, v14
    s_cbranch_vccnz K_RT_F
    ds_read_b128 v[80:83], v7 offset:50176
    ds_read_b64_tr_b16 v[88:89], v9 offset:16384
    ds_read_b64_tr_b16 v[90:91], v9 offset:18432
    v_mfma_f32_32x32x16_bf16 v[144:159], v[112:115], v[108:111], v[144:159]
    ds_read_b128 v[84:87], v7 offset:54272
    buffer_load_dwordx4 v58, s[44:47], s81 offen offset:2048 lds
    v_mfma_f32_32x32x16_bf16 v[160:175], v[116:119], v[104:107], v[160:175]
    ds_read_b64_tr_b16 v[92:93], v9 offset:17408
    ds_read_b64_tr_b16 v[94:95], v9 offset:19456
    v_mfma_f32_32x32x16_bf16 v[176:191], v[116:119], v[108:111], v[176:191]
    buffer_load_dwordx4 v58, s[48:51], s5 offen offset:3072 lds
    s_add_u32 m0, s36, 176
    s_mov_b64 exec, 1
    global_load_lds_dword v50, s[0:1]
    s_mov_b64 exec, -1
    s_waitcnt lgkmcnt(10)
    v_mfma_f32_32x32x16_bf16 v[192:207], v[120:123], v[104:107], v[192:207]
    ds_read_b64_tr_b16 v[96:97], v0 offset:16384
    ds_read_b64_tr_b16 v[98:99], v0 offset:18432
    v_mfma_f32_32x32x16_bf16 v[208:223], v[120:123], v[108:111], v[208:223]
    ds_read_b64_tr_b16 v[100:101], v0 offset:17408
    ds_read_b64_tr_b16 v[102:103], v0 offset:19456
    s_add_u32 m0, s80, 65536
    s_movk_i32 s6, 768
    buffer_load_dwordx4 v2, s[40:43], s6 offen offset:0 lds
    s_waitcnt lgkmcnt(12)
    v_mfma_f32_32x32x16_bf16 v[224:239], v[124:127], v[104:107], v[224:239]
    v_mfma_f32_32x32x16_bf16 v[240:255], v[124:127], v[108:111], v[240:255]
    buffer_load_dwordx4 v3, s[40:43], s6 offen offset:1024 lds
    ds_read_u8 v16, v11 offset:64
    s_waitcnt lgkmcnt(8)
    v_mfma_f32_32x32x16_bf16 v[128:143], v[88:91], v[80:83], v[128:143]
    ds_read_b128 v[104:107], v8 offset:50176
    ds_read_b64_tr_b16 v[112:113], v9 offset:24576
    ds_read_b64_tr_b16 v[114:115], v9 offset:26624
    s_waitcnt lgkmcnt(10)
    v_mfma_f32_32x32x16_bf16 v[144:159], v[88:91], v[84:87], v[144:159]
    ds_read_b128 v[108:111], v8 offset:54272
    v_readfirstlane_b32 s84, v22
    v_readfirstlane_b32 s85, v23
    buffer_load_dword v17, v15, s[52:55], 0 offen sc1
    s_waitcnt lgkmcnt(9)
    v_mfma_f32_32x32x16_bf16 v[160:175], v[92:95], v[80:83], v[160:175]
    ds_read_b64_tr_b16 v[116:117], v9 offset:25600
    ds_read_b64_tr_b16 v[118:119], v9 offset:27648
    v_mfma_f32_32x32x16_bf16 v[176:191], v[92:95], v[84:87], v[176:191]
    s_waitcnt lgkmcnt(6)
    s_getpc_b64 s[20:21]
    v_cmp_gt_u32 vcc, 9, v16
    s_cbranch_vccnz K_RT_R
    v_add_u32 v51, 16, v51
    ds_read_b32 v14, v51
    v_mfma_f32_32x32x16_bf16 v[192:207], v[96:99], v[80:83], v[192:207]
    ds_read_b64_tr_b16 v[120:121], v0 offset:24576
    ds_read_b64_tr_b16 v[122:123], v0 offset:26624
    buffer_load_dwordx4 v56, s[40:43], s6 offen offset:2048 lds
    v_mfma_f32_32x32x16_bf16 v[208:223], v[96:99], v[84:87], v[208:223]
    ds_read_b64_tr_b16 v[124:125], v0 offset:25600
    ds_read_b64_tr_b16 v[126:127], v0 offset:27648
    v_mov_b32 v13, 10
    ds_write_b8 v12, v13 offset:64
    v_mfma_f32_32x32x16_bf16 v[224:239], v[100:103], v[80:83], v[224:239]
    buffer_load_dwordx4 v57, s[40:43], s6 offen offset:3072 lds
    v_mfma_f32_32x32x16_bf16 v[240:255], v[100:103], v[84:87], v[240:255]
    s_waitcnt lgkmcnt(9)
    v_mfma_f32_32x32x16_bf16 v[128:143], v[112:115], v[104:107], v[128:143]
    s_waitcnt lgkmcnt(5)
    s_getpc_b64 s[20:21]
    v_cmp_gt_u32 vcc, 1, v14
    s_cbranch_vccnz K_RT_F
    ds_read_b128 v[80:83], v5 offset:16384
    ds_read_b64_tr_b16 v[88:89], v9 offset:32768
    ds_read_b64_tr_b16 v[90:91], v9 offset:34816
    v_mfma_f32_32x32x16_bf16 v[144:159], v[112:115], v[108:111], v[144:159]
    ds_read_b128 v[84:87], v5 offset:20480
    s_add_u32 m0, s80, 0
    s_mov_b32 s81, 1376256
    buffer_load_dwordx4 v4, s[44:47], s81 offen offset:0 lds
    v_mfma_f32_32x32x16_bf16 v[160:175], v[116:119], v[104:107], v[160:175]
    ds_read_b64_tr_b16 v[92:93], v9 offset:33792
    ds_read_b64_tr_b16 v[94:95], v9 offset:35840
    v_mfma_f32_32x32x16_bf16 v[176:191], v[116:119], v[108:111], v[176:191]
    s_mov_b32 s5, 1375232
    buffer_load_dwordx4 v4, s[48:51], s5 offen offset:1024 lds
    s_waitcnt lgkmcnt(9)
    v_mfma_f32_32x32x16_bf16 v[192:207], v[120:123], v[104:107], v[192:207]
    ds_read_b64_tr_b16 v[96:97], v0 offset:32768
    ds_read_b64_tr_b16 v[98:99], v0 offset:34816
    v_mfma_f32_32x32x16_bf16 v[208:223], v[120:123], v[108:111], v[208:223]
    ds_read_b64_tr_b16 v[100:101], v0 offset:33792
    ds_read_b64_tr_b16 v[102:103], v0 offset:35840
    buffer_load_dwordx4 v58, s[44:47], s81 offen offset:2048 lds
    s_waitcnt lgkmcnt(11)
    v_mfma_f32_32x32x16_bf16 v[224:239], v[124:127], v[104:107], v[224:239]
    v_mfma_f32_32x32x16_bf16 v[240:255], v[124:127], v[108:111], v[240:255]
    buffer_load_dwordx4 v58, s[48:51], s5 offen offset:3072 lds
    s_add_u32 m0, s36, 192
    s_mov_b64 exec, 1
    global_load_lds_dword v50, s[0:1]
    s_mov_b64 exec, -1
    ds_read_u8 v16, v11 offset:64
    s_waitcnt lgkmcnt(8)
    v_mfma_f32_32x32x16_bf16 v[128:143], v[88:91], v[80:83], v[128:143]
    ds_read_b128 v[104:107], v6 offset:16384
    ds_read_b64_tr_b16 v[112:113], v9 offset:40960
    ds_read_b64_tr_b16 v[114:115], v9 offset:43008
    s_waitcnt lgkmcnt(10)
    v_mfma_f32_32x32x16_bf16 v[144:159], v[88:91], v[84:87], v[144:159]
    ds_read_b128 v[108:111], v6 offset:20480
    s_waitcnt lgkmcnt(9)
    v_mfma_f32_32x32x16_bf16 v[160:175], v[92:95], v[80:83], v[160:175]
    ds_read_b64_tr_b16 v[116:117], v9 offset:41984
    ds_read_b64_tr_b16 v[118:119], v9 offset:44032
    v_mfma_f32_32x32x16_bf16 v[176:191], v[92:95], v[84:87], v[176:191]
    s_waitcnt lgkmcnt(6)
    s_getpc_b64 s[20:21]
    v_cmp_gt_u32 vcc, 10, v16
    s_cbranch_vccnz K_RT_R
    v_add_u32 v51, 16, v51
    ds_read_b32 v14, v51
    v_mfma_f32_32x32x16_bf16 v[192:207], v[96:99], v[80:83], v[192:207]
    ds_read_b64_tr_b16 v[120:121], v0 offset:40960
    ds_read_b64_tr_b16 v[122:123], v0 offset:43008
    s_add_u32 m0, s80, 16384
    s_mov_b32 s81, 1490944
    buffer_load_dwordx4 v4, s[44:47], s81 offen offset:0 lds
    v_mfma_f32_32x32x16_bf16 v[208:223], v[96:99], v[84:87], v[208:223]
    ds_read_b64_tr_b16 v[124:125], v0 offset:41984
    ds_read_b64_tr_b16 v[126:127], v0 offset:44032
    ds_read_b64 v[22:23], v10 offset:8
    v_mov_b32 v13, 11
    ds_write_b8 v12, v13 offset:64
    v_mfma_f32_32x32x16_bf16 v[224:239], v[100:103], v[80:83], v[224:239]
    s_mov_b32 s5, 1489920
    buffer_load_dwordx4 v4, s[48:51], s5 offen offset:1024 lds
    v_mfma_f32_32x32x16_bf16 v[240:255], v[100:103], v[84:87], v[240:255]
    s_waitcnt lgkmcnt(10)
    v_mfma_f32_32x32x16_bf16 v[128:143], v[112:115], v[104:107], v[128:143]
    s_waitcnt lgkmcnt(6)
    s_getpc_b64 s[20:21]
    v_cmp_gt_u32 vcc, 1, v14
    s_cbranch_vccnz K_RT_F
    ds_read_b128 v[80:83], v7 offset:16384
    ds_read_b64_tr_b16 v[88:89], v9 offset:49152
    ds_read_b64_tr_b16 v[90:91], v9 offset:51200
    v_mfma_f32_32x32x16_bf16 v[144:159], v[112:115], v[108:111], v[144:159]
    ds_read_b128 v[84:87], v7 offset:20480
    buffer_load_dwordx4 v58, s[44:47], s81 offen offset:2048 lds
    v_mfma_f32_32x32x16_bf16 v[160:175], v[116:119], v[104:107], v[160:175]
    ds_read_b64_tr_b16 v[92:93], v9 offset:50176
    ds_read_b64_tr_b16 v[94:95], v9 offset:52224
    v_mfma_f32_32x32x16_bf16 v[176:191], v[116:119], v[108:111], v[176:191]
    buffer_load_dwordx4 v58, s[48:51], s5 offen offset:3072 lds
    s_add_u32 m0, s36, 208
    s_mov_b64 exec, 1
    global_load_lds_dword v50, s[0:1]
    s_mov_b64 exec, -1
    s_waitcnt lgkmcnt(10)
    v_mfma_f32_32x32x16_bf16 v[192:207], v[120:123], v[104:107], v[192:207]
    ds_read_b64_tr_b16 v[96:97], v0 offset:49152
    ds_read_b64_tr_b16 v[98:99], v0 offset:51200
    v_mfma_f32_32x32x16_bf16 v[208:223], v[120:123], v[108:111], v[208:223]
    ds_read_b64_tr_b16 v[100:101], v0 offset:50176
    ds_read_b64_tr_b16 v[102:103], v0 offset:52224
    s_waitcnt lgkmcnt(12)
    v_mfma_f32_32x32x16_bf16 v[224:239], v[124:127], v[104:107], v[224:239]
    v_mfma_f32_32x32x16_bf16 v[240:255], v[124:127], v[108:111], v[240:255]
    ds_read_u8 v16, v11 offset:64
    s_waitcnt lgkmcnt(8)
    v_mfma_f32_32x32x16_bf16 v[128:143], v[88:91], v[80:83], v[128:143]
    ds_read_b128 v[104:107], v8 offset:16384
    ds_read_b64_tr_b16 v[112:113], v9 offset:57344
    ds_read_b64_tr_b16 v[114:115], v9 offset:59392
    s_waitcnt vmcnt(12)
    v_cmp_ne_u32 vcc, s84, v17
    s_cbranch_vccz CLO_2
CL_1:
    s_waitcnt lgkmcnt(10)
    v_mfma_f32_32x32x16_bf16 v[144:159], v[88:91], v[84:87], v[144:159]
    ds_read_b128 v[108:111], v8 offset:20480
    v_readfirstlane_b32 s84, v22
    v_readfirstlane_b32 s85, v23
    buffer_load_dword v17, v15, s[52:55], 0 offen sc1
    s_waitcnt lgkmcnt(9)
    v_mfma_f32_32x32x16_bf16 v[160:175], v[92:95], v[80:83], v[160:175]
    ds_read_b64_tr_b16 v[116:117], v9 offset:58368
    ds_read_b64_tr_b16 v[118:119], v9 offset:60416
    v_mfma_f32_32x32x16_bf16 v[176:191], v[92:95], v[84:87], v[176:191]
    s_waitcnt lgkmcnt(6)
    s_getpc_b64 s[20:21]
    v_cmp_gt_u32 vcc, 11, v16
    s_cbranch_vccnz K_RT_R
    v_add_u32 v51, 16, v51
    ds_read_b32 v14, v51
    v_mfma_f32_32x32x16_bf16 v[192:207], v[96:99], v[80:83], v[192:207]
    ds_read_b64_tr_b16 v[120:121], v0 offset:57344
    ds_read_b64_tr_b16 v[122:123], v0 offset:59392
    s_add_u32 m0, s80, 32768
    s_mov_b32 s81, 0
    buffer_load_dwordx4 v52, s[56:59], s81 offen offset:0 lds
    v_mfma_f32_32x32x16_bf16 v[208:223], v[96:99], v[84:87], v[208:223]
    ds_read_b64_tr_b16 v[124:125], v0 offset:58368
    ds_read_b64_tr_b16 v[126:127], v0 offset:60416
    v_mov_b32 v13, 12
    ds_write_b8 v12, v13 offset:64
    v_mfma_f32_32x32x16_bf16 v[224:239], v[100:103], v[80:83], v[224:239]
    buffer_load_dwordx4 v53, s[56:59], s81 offen offset:1024 lds
    v_mfma_f32_32x32x16_bf16 v[240:255], v[100:103], v[84:87], v[240:255]
    s_waitcnt lgkmcnt(9)
    v_mfma_f32_32x32x16_bf16 v[128:143], v[112:115], v[104:107], v[128:143]
    s_waitcnt lgkmcnt(5)
    s_getpc_b64 s[20:21]
    v_cmp_gt_u32 vcc, 1, v14
    s_cbranch_vccnz K_RT_F
    ds_read_b128 v[80:83], v5 offset:0
    ds_read_b64_tr_b16 v[88:89], v9 offset:0
    ds_read_b64_tr_b16 v[90:91], v9 offset:2048
    v_mfma_f32_32x32x16_bf16 v[144:159], v[112:115], v[108:111], v[144:159]
    ds_read_b128 v[84:87], v5 offset:4096
    buffer_load_dwordx4 v54, s[56:59], s81 offen offset:2048 lds
    v_mfma_f32_32x32x16_bf16 v[160:175], v[116:119], v[104:107], v[160:175]
    ds_read_b64_tr_b16 v[92:93], v9 offset:1024
    ds_read_b64_tr_b16 v[94:95], v9 offset:3072
    v_mfma_f32_32x32x16_bf16 v[176:191], v[116:119], v[108:111], v[176:191]
    buffer_load_dwordx4 v55, s[56:59], s81 offen offset:3072 lds
    s_waitcnt lgkmcnt(9)
    v_mfma_f32_32x32x16_bf16 v[192:207], v[120:123], v[104:107], v[192:207]
    ds_read_b64_tr_b16 v[96:97], v0 offset:0
    ds_read_b64_tr_b16 v[98:99], v0 offset:2048
    v_mfma_f32_32x32x16_bf16 v[208:223], v[120:123], v[108:111], v[208:223]
    ds_read_b64_tr_b16 v[100:101], v0 offset:1024
    ds_read_b64_tr_b16 v[102:103], v0 offset:3072
    s_waitcnt lgkmcnt(11)
    v_mfma_f32_32x32x16_bf16 v[224:239], v[124:127], v[104:107], v[224:239]
    v_mfma_f32_32x32x16_bf16 v[240:255], v[124:127], v[108:111], v[240:255]
    ds_read_u8 v16, v11 offset:64
    s_waitcnt lgkmcnt(8)
    v_mfma_f32_32x32x16_bf16 v[128:143], v[88:91], v[80:83], v[128:143]
    ds_read_b128 v[104:107], v6 offset:0
    ds_read_b64_tr_b16 v[112:113], v9 offset:8192
    ds_read_b64_tr_b16 v[114:115], v9 offset:10240
    s_waitcnt lgkmcnt(10)
    v_mfma_f32_32x32x16_bf16 v[144:159], v[88:91], v[84:87], v[144:159]
    ds_read_b128 v[108:111], v6 offset:4096
    s_waitcnt lgkmcnt(9)
    v_mfma_f32_32x32x16_bf16 v[160:175], v[92:95], v[80:83], v[160:175]
    ds_read_b64_tr_b16 v[116:117], v9 offset:9216
    ds_read_b64_tr_b16 v[118:119], v9 offset:11264
    v_mfma_f32_32x32x16_bf16 v[176:191], v[92:95], v[84:87], v[176:191]
    s_waitcnt lgkmcnt(6)
    s_getpc_b64 s[20:21]
    v_cmp_gt_u32 vcc, 12, v16
    s_cbranch_vccnz K_RT_R
    v_add_u32 v51, 16, v51
    ds_read_b32 v14, v51
    v_mfma_f32_32x32x16_bf16 v[192:207], v[96:99], v[80:83], v[192:207]
    ds_read_b64_tr_b16 v[120:121], v0 offset:8192
    ds_read_b64_tr_b16 v[122:123], v0 offset:10240
    s_add_u32 m0, s80, 49152
    s_mov_b32 s81, 57344
    buffer_load_dwordx4 v52, s[56:59], s81 offen offset:0 lds
    v_mfma_f32_32x32x16_bf16 v[208:223], v[96:99], v[84:87], v[208:223]
    ds_read_b64_tr_b16 v[124:125], v0 offset:9216
    ds_read_b64_tr_b16 v[126:127], v0 offset:11264
    v_mov_b32 v13, 13
    ds_write_b8 v12, v13 offset:64
    v_mfma_f32_32x32x16_bf16 v[224:239], v[100:103], v[80:83], v[224:239]
    buffer_load_dwordx4 v53, s[56:59], s81 offen offset:1024 lds
    v_mfma_f32_32x32x16_bf16 v[240:255], v[100:103], v[84:87], v[240:255]
    s_waitcnt lgkmcnt(9)
    v_mfma_f32_32x32x16_bf16 v[128:143], v[112:115], v[104:107], v[128:143]
    s_waitcnt lgkmcnt(5)
    s_getpc_b64 s[20:21]
    v_cmp_gt_u32 vcc, 1, v14
    s_cbranch_vccnz K_RT_F
    ds_read_b128 v[80:83], v7 offset:0
    ds_read_b64_tr_b16 v[88:89], v9 offset:16384
    ds_read_b64_tr_b16 v[90:91], v9 offset:18432
    v_mfma_f32_32x32x16_bf16 v[144:159], v[112:115], v[108:111], v[144:159]
    ds_read_b128 v[84:87], v7 offset:4096
    buffer_load_dwordx4 v54, s[56:59], s81 offen offset:2048 lds
    v_mfma_f32_32x32x16_bf16 v[160:175], v[116:119], v[104:107], v[160:175]
    ds_read_b64_tr_b16 v[92:93], v9 offset:17408
    ds_read_b64_tr_b16 v[94:95], v9 offset:19456
    v_mfma_f32_32x32x16_bf16 v[176:191], v[116:119], v[108:111], v[176:191]
    buffer_load_dwordx4 v55, s[56:59], s81 offen offset:3072 lds
    s_waitcnt lgkmcnt(9)
    v_mfma_f32_32x32x16_bf16 v[192:207], v[120:123], v[104:107], v[192:207]
    ds_read_b64_tr_b16 v[96:97], v0 offset:16384
    ds_read_b64_tr_b16 v[98:99], v0 offset:18432
    v_mfma_f32_32x32x16_bf16 v[208:223], v[120:123], v[108:111], v[208:223]
    ds_read_b64_tr_b16 v[100:101], v0 offset:17408
    ds_read_b64_tr_b16 v[102:103], v0 offset:19456
    s_add_u32 m0, s80, 81920
    s_mov_b32 s81, 114688
    buffer_load_dwordx4 v52, s[56:59], s81 offen offset:0 lds
    s_waitcnt lgkmcnt(11)
    v_mfma_f32_32x32x16_bf16 v[224:239], v[124:127], v[104:107], v[224:239]
    v_mfma_f32_32x32x16_bf16 v[240:255], v[124:127], v[108:111], v[240:255]
    buffer_load_dwordx4 v53, s[56:59], s81 offen offset:1024 lds
    ds_read_u8 v16, v11 offset:64
    s_waitcnt lgkmcnt(8)
    v_mfma_f32_32x32x16_bf16 v[128:143], v[88:91], v[80:83], v[128:143]
    ds_read_b128 v[104:107], v8 offset:0
    ds_read_b64_tr_b16 v[112:113], v9 offset:24576
    ds_read_b64_tr_b16 v[114:115], v9 offset:26624
    s_waitcnt vmcnt(10)
    v_cmp_ne_u32 vcc, s84, v17
    s_cbranch_vccz CLO_4
CL_3:
    s_waitcnt lgkmcnt(10)
    v_mfma_f32_32x32x16_bf16 v[144:159], v[88:91], v[84:87], v[144:159]
    ds_read_b128 v[108:111], v8 offset:4096
    s_waitcnt lgkmcnt(9)
    v_mfma_f32_32x32x16_bf16 v[160:175], v[92:95], v[80:83], v[160:175]
    ds_read_b64_tr_b16 v[116:117], v9 offset:25600
    ds_read_b64_tr_b16 v[118:119], v9 offset:27648
    v_mfma_f32_32x32x16_bf16 v[176:191], v[92:95], v[84:87], v[176:191]
    s_waitcnt lgkmcnt(6)
    s_getpc_b64 s[20:21]
    v_cmp_gt_u32 vcc, 13, v16
    s_cbranch_vccnz K_RT_R
    v_mfma_f32_32x32x16_bf16 v[192:207], v[96:99], v[80:83], v[192:207]
    ds_read_b64_tr_b16 v[120:121], v0 offset:24576
    ds_read_b64_tr_b16 v[122:123], v0 offset:26624
    buffer_load_dwordx4 v54, s[56:59], s81 offen offset:2048 lds
    v_mfma_f32_32x32x16_bf16 v[208:223], v[96:99], v[84:87], v[208:223]
    ds_read_b64_tr_b16 v[124:125], v0 offset:25600
    ds_read_b64_tr_b16 v[126:127], v0 offset:27648
    v_mov_b32 v13, 14
    ds_write_b8 v12, v13 offset:64
    v_mfma_f32_32x32x16_bf16 v[224:239], v[100:103], v[80:83], v[224:239]
    buffer_load_dwordx4 v55, s[56:59], s81 offen offset:3072 lds
    v_mfma_f32_32x32x16_bf16 v[240:255], v[100:103], v[84:87], v[240:255]
    s_waitcnt lgkmcnt(8)
    v_mfma_f32_32x32x16_bf16 v[128:143], v[112:115], v[104:107], v[128:143]
    s_waitcnt lgkmcnt(7)
    v_mfma_f32_32x32x16_bf16 v[144:159], v[112:115], v[108:111], v[144:159]
    s_add_u32 m0, s80, 0
    s_mov_b32 s81, 172032
    buffer_load_dwordx4 v52, s[56:59], s81 offen offset:0 lds
    s_waitcnt lgkmcnt(5)
    v_mfma_f32_32x32x16_bf16 v[160:175], v[116:119], v[104:107], v[160:175]
    v_mfma_f32_32x32x16_bf16 v[176:191], v[116:119], v[108:111], v[176:191]
    buffer_load_dwordx4 v53, s[56:59], s81 offen offset:1024 lds
    s_waitcnt lgkmcnt(3)
    v_mfma_f32_32x32x16_bf16 v[192:207], v[120:123], v[104:107], v[192:207]
    v_mfma_f32_32x32x16_bf16 v[208:223], v[120:123], v[108:111], v[208:223]
    buffer_load_dwordx4 v54, s[56:59], s81 offen offset:2048 lds
    s_waitcnt lgkmcnt(1)
    v_mfma_f32_32x32x16_bf16 v[224:239], v[124:127], v[104:107], v[224:239]
    v_mfma_f32_32x32x16_bf16 v[240:255], v[124:127], v[108:111], v[240:255]
    buffer_load_dwordx4 v55, s[56:59], s81 offen offset:3072 lds
    ds_read_u8 v16, v11 offset:64
    s_setprio 1
    s_cmp_eq_u32 s75, 0
    s_cbranch_scc1 CLO_6
    s_waitcnt vmcnt(6)
CL_5:
    v_mov_b32 v42, v24
    v_mov_b32 v46, v28
    s_nop 0
    v_mfma_f32_32x32x16_bf16 v[128:143], v[32:35], v[42:45], v[128:143]
    v_mfma_f32_32x32x16_bf16 v[160:175], v[34:37], v[42:45], v[160:175]
    v_mov_b32 v2, v52
    s_lshl_b32 s76, s73, 2
    s_add_u32 s76, s76, s68
    s_lshl_b32 s76, s76, 11
    s_add_u32 s76, s76, 7340032
    v_lshrrev_b32 v8, 1, v1
    v_lshlrev_b32 v8, 8, v8
    v_and_b32 v14, 1, v1
    v_lshl_add_u32 v8, v14, 2, v8
    v_add_u32 v8, s76, v8
    v_mfma_f32_32x32x16_bf16 v[144:159], v[32:35], v[46:49], v[144:159]
    v_bfe_u32 v13, v1, 2, 2
    v_lshrrev_b32 v14, 4, v1
    v_lshl_add_u32 v13, v14, 3, v13
    v_lshlrev_b32 v13, 7, v13
    v_and_b32 v14, 3, v1
    v_lshl_add_u32 v13, v14, 5, v13
    v_bfe_u32 v14, v1, 3, 1
    v_lshl_add_u32 v13, v14, 4, v13
    v_add_u32 v4, s80, v13
    v_xor_b32 v5, 16, v4
    v_add_u32 v6, 65536, v4
    v_add_u32 v7, 65536, v5
    v_mfma_f32_32x32x16_bf16 v[176:191], v[34:37], v[46:49], v[176:191]
    s_mov_b32 s37, 0
    s_waitcnt lgkmcnt(0)
    s_getpc_b64 s[20:21]
    v_cmp_gt_u32 vcc, 14, v16
    s_cbranch_vccnz K_RT_R
    v_mul_f32 v64, v128, v128
    s_add_u32 m0, s80, 16384
    s_mov_b32 s81, 229376
    buffer_load_dwordx4 v52, s[56:59], s81 offen offset:0 lds
    v_mfma_f32_32x32x16_bf16 v[192:207], v[36:39], v[42:45], v[192:207]
    buffer_load_dwordx4 v53, s[56:59], s81 offen offset:1024 lds
    v_mfma_f32_32x32x16_bf16 v[224:239], v[38:41], v[42:45], v[224:239]
    v_mul_f32 v65, v129, v129
    buffer_load_dwordx4 v54, s[56:59], s81 offen offset:2048 lds
    v_fma_f32 v64, v64, v26, v25
    v_mfma_f32_32x32x16_bf16 v[208:223], v[36:39], v[46:49], v[208:223]
    buffer_load_dwordx4 v55, s[56:59], s81 offen offset:3072 lds
    v_mul_f32 v66, v130, v130
    v_mfma_f32_32x32x16_bf16 v[240:255], v[38:41], v[46:49], v[240:255]
    v_fma_f32 v65, v65, v26, v25
    v_mul_f32 v64, v64, v128
    s_add_u32 m0, s80, 65536
    s_mov_b32 s81, 286720
    buffer_load_dwordx4 v52, s[56:59], s81 offen offset:0 lds
    v_mul_f32 v67, v131, v131
    v_fma_f32 v66, v66, v26, v25
    buffer_load_dwordx4 v53, s[56:59], s81 offen offset:1024 lds
    v_mul_f32 v65, v65, v129
    v_exp_f32 v64, v64
    buffer_load_dwordx4 v54, s[56:59], s81 offen offset:2048 lds
    v_mul_f32 v68, v132, v132
    v_fma_f32 v67, v67, v26, v25
    buffer_load_dwordx4 v55, s[56:59], s81 offen offset:3072 lds
    v_mul_f32 v66, v66, v130
    v_exp_f32 v65, v65
    v_mul_f32 v128, v128, v160
    v_mul_f32 v69, v133, v133
    v_fma_f32 v68, v68, v26, v25
    v_mul_f32 v67, v67, v131
    v_exp_f32 v66, v66
    v_mul_f32 v129, v129, v161
    v_mul_f32 v70, v134, v134
    v_fma_f32 v64, v64, v27, v27
    v_fma_f32 v69, v69, v26, v25
    v_mul_f32 v68, v68, v132
    v_exp_f32 v67, v67
    v_mul_f32 v130, v130, v162
    v_mul_f32 v71, v135, v135
    v_fma_f32 v65, v65, v27, v27
    v_fma_f32 v70, v70, v26, v25
    v_rcp_f32 v64, v64
    v_mul_f32 v69, v69, v133
    v_exp_f32 v68, v68
    v_mul_f32 v131, v131, v163
    v_mul_f32 v72, v136, v136
    v_fma_f32 v66, v66, v27, v27
    v_fma_f32 v71, v71, v26, v25
    v_rcp_f32 v65, v65
    v_mul_f32 v70, v70, v134
    v_mul_f32 v128, v128, v64
    v_exp_f32 v69, v69
    v_mul_f32 v132, v132, v164
    v_mul_f32 v73, v137, v137
    v_fma_f32 v67, v67, v27, v27
    v_fma_f32 v72, v72, v26, v25
    v_rcp_f32 v66, v66
    v_mul_f32 v71, v71, v135
    v_mul_f32 v129, v129, v65
    v_exp_f32 v70, v70
    v_mul_f32 v133, v133, v165
    v_mul_f32 v74, v138, v138
    v_fma_f32 v68, v68, v27, v27
    v_fma_f32 v73, v73, v26, v25
    v_rcp_f32 v67, v67
    v_mul_f32 v72, v72, v136
    v_mul_f32 v130, v130, v66
    v_exp_f32 v71, v71
    v_cvt_pk_bf16_f32 v112, v128, v129
    v_mul_f32 v134, v134, v166
    v_mul_f32 v75, v139, v139
    v_fma_f32 v69, v69, v27, v27
    v_fma_f32 v74, v74, v26, v25
    v_rcp_f32 v68, v68
    v_mul_f32 v73, v73, v137
    v_mul_f32 v131, v131, v67
    v_exp_f32 v72, v72
    v_mul_f32 v135, v135, v167
    v_mul_f32 v76, v140, v140
    v_fma_f32 v70, v70, v27, v27
    v_fma_f32 v75, v75, v26, v25
    v_rcp_f32 v69, v69
    v_mul_f32 v74, v74, v138
    v_mul_f32 v132, v132, v68
    v_exp_f32 v73, v73
    v_cvt_pk_bf16_f32 v113, v130, v131
    v_mul_f32 v136, v136, v168
    v_mul_f32 v77, v141, v141
    v_fma_f32 v71, v71, v27, v27
    v_fma_f32 v76, v76, v26, v25
    v_rcp_f32 v70, v70
    v_mul_f32 v75, v75, v139
    v_mul_f32 v133, v133, v69
    v_exp_f32 v74, v74
    v_mul_f32 v137, v137, v169
    v_mul_f32 v78, v142, v142
    v_fma_f32 v72, v72, v27, v27
    v_fma_f32 v77, v77, v26, v25
    v_rcp_f32 v71, v71
    v_mul_f32 v76, v76, v140
    v_mul_f32 v134, v134, v70
    v_exp_f32 v75, v75
    v_cvt_pk_bf16_f32 v114, v132, v133
    v_mul_f32 v138, v138, v170
    v_mul_f32 v79, v143, v143
    v_fma_f32 v73, v73, v27, v27
    v_fma_f32 v78, v78, v26, v25
    v_rcp_f32 v72, v72
    v_mul_f32 v77, v77, v141
    v_mul_f32 v135, v135, v71
    v_exp_f32 v76, v76
    v_mul_f32 v139, v139, v171
    v_mul_f32 v64, v144, v144
    v_fma_f32 v74, v74, v27, v27
    v_fma_f32 v79, v79, v26, v25
    v_rcp_f32 v73, v73
    v_mul_f32 v78, v78, v142
    v_mul_f32 v136, v136, v72
    v_exp_f32 v77, v77
    v_cvt_pk_bf16_f32 v115, v134, v135
    v_mul_f32 v140, v140, v172
    v_mul_f32 v65, v145, v145
    v_fma_f32 v75, v75, v27, v27
    v_permlane32_swap_b32 v112, v114
    v_fma_f32 v64, v64, v30, v29
    v_permlane32_swap_b32 v113, v115
    v_rcp_f32 v74, v74
    v_mul_f32 v79, v79, v143
    v_mul_f32 v137, v137, v73
    s_movk_i32 s76, 0
    buffer_store_dwordx4 v[112:115], v20, s[52:55], s76 offen offset:0 sc1
    v_exp_f32 v78, v78
    v_mul_f32 v141, v141, v173
    v_mul_f32 v66, v146, v146
    v_fma_f32 v76, v76, v27, v27
    v_fma_f32 v65, v65, v30, v29
    v_rcp_f32 v75, v75
    v_mul_f32 v64, v64, v144
    v_mul_f32 v138, v138, v74
    v_exp_f32 v79, v79
    v_cvt_pk_bf16_f32 v116, v136, v137
    v_mul_f32 v142, v142, v174
    v_mul_f32 v67, v147, v147
    v_fma_f32 v77, v77, v27, v27
    v_fma_f32 v66, v66, v30, v29
    v_rcp_f32 v76, v76
    v_mul_f32 v65, v65, v145
    v_mul_f32 v139, v139, v75
    v_exp_f32 v64, v64
    v_mul_f32 v143, v143, v175
    v_mul_f32 v68, v148, v148
    v_fma_f32 v78, v78, v27, v27
    v_fma_f32 v67, v67, v30, v29
    v_rcp_f32 v77, v77
    v_mul_f32 v66, v66, v146
    v_mul_f32 v140, v140, v76
    v_exp_f32 v65, v65
    v_cvt_pk_bf16_f32 v117, v138, v139
    v_mul_f32 v144, v144, v176
    v_mul_f32 v69, v149, v149
    v_fma_f32 v79, v79, v27, v27
    v_fma_f32 v68, v68, v30, v29
    v_rcp_f32 v78, v78
    v_mul_f32 v67, v67, v147
    v_mul_f32 v141, v141, v77
    v_exp_f32 v66, v66
    v_mul_f32 v145, v145, v177
    v_mul_f32 v70, v150, v150
    v_fma_f32 v64, v64, v31, v31
    v_fma_f32 v69, v69, v30, v29
    v_rcp_f32 v79, v79
    v_mul_f32 v68, v68, v148
    v_mul_f32 v142, v142, v78
    v_exp_f32 v67, v67
    v_cvt_pk_bf16_f32 v118, v140, v141
    v_mul_f32 v146, v146, v178
    v_mul_f32 v71, v151, v151
    v_fma_f32 v65, v65, v31, v31
    v_fma_f32 v70, v70, v30, v29
    v_rcp_f32 v64, v64
    v_mul_f32 v69, v69, v149
    v_mul_f32 v143, v143, v79
    v_exp_f32 v68, v68
    v_mul_f32 v147, v147, v179
    v_mul_f32 v72, v152, v152
    v_fma_f32 v66, v66, v31, v31
    v_fma_f32 v71, v71, v30, v29
    v_rcp_f32 v65, v65
    v_mul_f32 v70, v70, v150
    v_mul_f32 v144, v144, v64
    v_exp_f32 v69, v69
    v_cvt_pk_bf16_f32 v119, v142, v143
    v_mul_f32 v148, v148, v180
    v_mul_f32 v73, v153, v153
    v_fma_f32 v67, v67, v31, v31
    v_permlane32_swap_b32 v116, v118
    v_fma_f32 v72, v72, v30, v29
    v_permlane32_swap_b32 v117, v119
    v_rcp_f32 v66, v66
    v_mul_f32 v71, v71, v151
    v_mul_f32 v145, v145, v65
    s_movk_i32 s76, 0
    buffer_store_dwordx4 v[116:119], v20, s[52:55], s76 offen offset:512 sc1
    v_exp_f32 v70, v70
    v_mul_f32 v149, v149, v181
    v_mul_f32 v74, v154, v154
    v_fma_f32 v68, v68, v31, v31
    v_fma_f32 v73, v73, v30, v29
    v_rcp_f32 v67, v67
    v_mul_f32 v72, v72, v152
    v_mul_f32 v146, v146, v66
    v_exp_f32 v71, v71
    v_cvt_pk_bf16_f32 v120, v144, v145
    v_mul_f32 v150, v150, v182
    v_mul_f32 v75, v155, v155
    v_fma_f32 v69, v69, v31, v31
    v_fma_f32 v74, v74, v30, v29
    v_rcp_f32 v68, v68
    v_mul_f32 v73, v73, v153
    v_mul_f32 v147, v147, v67
    v_exp_f32 v72, v72
    v_mul_f32 v151, v151, v183
    v_mul_f32 v76, v156, v156
    v_fma_f32 v70, v70, v31, v31
    v_fma_f32 v75, v75, v30, v29
    v_rcp_f32 v69, v69
    v_mul_f32 v74, v74, v154
    v_mul_f32 v148, v148, v68
    v_exp_f32 v73, v73
    v_cvt_pk_bf16_f32 v121, v146, v147
    v_mul_f32 v152, v152, v184
    v_mul_f32 v77, v157, v157
    v_fma_f32 v71, v71, v31, v31
    v_fma_f32 v76, v76, v30, v29
    v_rcp_f32 v70, v70
    v_mul_f32 v75, v75, v155
    v_mul_f32 v149, v149, v69
    v_exp_f32 v74, v74
    v_mul_f32 v153, v153, v185
    v_mul_f32 v78, v158, v158
    v_fma_f32 v72, v72, v31, v31
    v_fma_f32 v77, v77, v30, v29
    v_rcp_f32 v71, v71
    v_mul_f32 v76, v76, v156
    v_mul_f32 v150, v150, v70
    v_exp_f32 v75, v75
    v_cvt_pk_bf16_f32 v122, v148, v149
    v_mul_f32 v154, v154, v186
    v_mul_f32 v79, v159, v159
    v_fma_f32 v73, v73, v31, v31
    v_fma_f32 v78, v78, v30, v29
    v_rcp_f32 v72, v72
    v_mul_f32 v77, v77, v157
    v_mul_f32 v151, v151, v71
    v_exp_f32 v76, v76
    v_mul_f32 v155, v155, v187
    v_mul_f32 v64, v192, v192
    v_fma_f32 v74, v74, v31, v31
    v_fma_f32 v79, v79, v30, v29
    v_rcp_f32 v73, v73
    v_mul_f32 v78, v78, v158
    v_mul_f32 v152, v152, v72
    v_exp_f32 v77, v77
    v_cvt_pk_bf16_f32 v123, v150, v151
    v_mul_f32 v156, v156, v188
    v_mul_f32 v65, v193, v193
    v_fma_f32 v75, v75, v31, v31
    v_permlane32_swap_b32 v120, v122
    v_fma_f32 v64, v64, v26, v25
    v_permlane32_swap_b32 v121, v123
    v_rcp_f32 v74, v74
    v_mul_f32 v79, v79, v159
    v_mul_f32 v153, v153, v73
    s_movk_i32 s76, 0
    buffer_store_dwordx4 v[120:123], v20, s[52:55], s76 offen offset:2048 sc1
    v_exp_f32 v78, v78
    v_mul_f32 v157, v157, v189
    v_mul_f32 v66, v194, v194
    v_fma_f32 v76, v76, v31, v31
    v_fma_f32 v65, v65, v26, v25
    v_rcp_f32 v75, v75
    v_mul_f32 v64, v64, v192
    v_mul_f32 v154, v154, v74
    v_exp_f32 v79, v79
    v_cvt_pk_bf16_f32 v124, v152, v153
    v_mul_f32 v158, v158, v190
    v_mul_f32 v67, v195, v195
    v_fma_f32 v77, v77, v31, v31
    v_fma_f32 v66, v66, v26, v25
    v_rcp_f32 v76, v76
    v_mul_f32 v65, v65, v193
    v_mul_f32 v155, v155, v75
    v_exp_f32 v64, v64
    v_mul_f32 v159, v159, v191
    v_mul_f32 v68, v196, v196
    v_fma_f32 v78, v78, v31, v31
    v_fma_f32 v67, v67, v26, v25
    v_rcp_f32 v77, v77
    v_mul_f32 v66, v66, v194
    v_mul_f32 v156, v156, v76
    v_exp_f32 v65, v65
    v_cvt_pk_bf16_f32 v125, v154, v155
    v_mul_f32 v192, v192, v224
    v_mul_f32 v69, v197, v197
    v_fma_f32 v79, v79, v31, v31
    v_fma_f32 v68, v68, v26, v25
    v_rcp_f32 v78, v78
    v_mul_f32 v67, v67, v195
    v_mul_f32 v157, v157, v77
    v_exp_f32 v66, v66
    v_mul_f32 v193, v193, v225
    v_mul_f32 v70, v198, v198
    v_fma_f32 v64, v64, v27, v27
    v_fma_f32 v69, v69, v26, v25
    v_rcp_f32 v79, v79
    v_mul_f32 v68, v68, v196
    v_mul_f32 v158, v158, v78
    v_exp_f32 v67, v67
    v_cvt_pk_bf16_f32 v126, v156, v157
    v_mul_f32 v194, v194, v226
    v_mul_f32 v71, v199, v199
    v_fma_f32 v65, v65, v27, v27
    v_fma_f32 v70, v70, v26, v25
    v_rcp_f32 v64, v64
    v_mul_f32 v69, v69, v197
    v_mul_f32 v159, v159, v79
    v_exp_f32 v68, v68
    v_mul_f32 v195, v195, v227
    v_mul_f32 v72, v200, v200
    v_fma_f32 v66, v66, v27, v27
    v_fma_f32 v71, v71, v26, v25
    v_rcp_f32 v65, v65
    v_mul_f32 v70, v70, v198
    v_mul_f32 v192, v192, v64
    v_exp_f32 v69, v69
    v_cvt_pk_bf16_f32 v127, v158, v159
    v_mul_f32 v196, v196, v228
    v_mul_f32 v73, v201, v201
    v_fma_f32 v67, v67, v27, v27
    v_permlane32_swap_b32 v124, v126
    v_fma_f32 v72, v72, v26, v25
    v_permlane32_swap_b32 v125, v127
    v_rcp_f32 v66, v66
    v_mul_f32 v71, v71, v199
    v_mul_f32 v193, v193, v65
    s_movk_i32 s76, 0
    buffer_store_dwordx4 v[124:127], v20, s[52:55], s76 offen offset:2560 sc1
    v_exp_f32 v70, v70
    v_mul_f32 v197, v197, v229
    v_mul_f32 v74, v202, v202
    v_fma_f32 v68, v68, v27, v27
    v_fma_f32 v73, v73, v26, v25
    v_rcp_f32 v67, v67
    v_mul_f32 v72, v72, v200
    v_mul_f32 v194, v194, v66
    v_exp_f32 v71, v71
    v_cvt_pk_bf16_f32 v112, v192, v193
    v_mul_f32 v198, v198, v230
    v_mul_f32 v75, v203, v203
    v_fma_f32 v69, v69, v27, v27
    v_fma_f32 v74, v74, v26, v25
    v_rcp_f32 v68, v68
    v_mul_f32 v73, v73, v201
    v_mul_f32 v195, v195, v67
    v_exp_f32 v72, v72
    v_mul_f32 v199, v199, v231
    v_mul_f32 v76, v204, v204
    v_fma_f32 v70, v70, v27, v27
    v_fma_f32 v75, v75, v26, v25
    v_rcp_f32 v69, v69
    v_mul_f32 v74, v74, v202
    v_mul_f32 v196, v196, v68
    v_exp_f32 v73, v73
    v_cvt_pk_bf16_f32 v113, v194, v195
    v_mul_f32 v200, v200, v232
    v_mul_f32 v77, v205, v205
    v_fma_f32 v71, v71, v27, v27
    v_fma_f32 v76, v76, v26, v25
    v_rcp_f32 v70, v70
    v_mul_f32 v75, v75, v203
    v_mul_f32 v197, v197, v69
    v_exp_f32 v74, v74
    v_mul_f32 v201, v201, v233
    v_mul_f32 v78, v206, v206
    v_fma_f32 v72, v72, v27, v27
    v_fma_f32 v77, v77, v26, v25
    v_rcp_f32 v71, v71
    v_mul_f32 v76, v76, v204
    v_mul_f32 v198, v198, v70
    v_exp_f32 v75, v75
    v_cvt_pk_bf16_f32 v114, v196, v197
    v_mul_f32 v202, v202, v234
    v_mul_f32 v79, v207, v207
    v_fma_f32 v73, v73, v27, v27
    v_fma_f32 v78, v78, v26, v25
    v_rcp_f32 v72, v72
    v_mul_f32 v77, v77, v205
    v_mul_f32 v199, v199, v71
    v_exp_f32 v76, v76
    v_mul_f32 v203, v203, v235
    v_mul_f32 v64, v208, v208
    v_fma_f32 v74, v74, v27, v27
    v_fma_f32 v79, v79, v26, v25
    v_rcp_f32 v73, v73
    v_mul_f32 v78, v78, v206
    v_mul_f32 v200, v200, v72
    v_exp_f32 v77, v77
    v_cvt_pk_bf16_f32 v115, v198, v199
    v_mul_f32 v204, v204, v236
    v_mul_f32 v65, v209, v209
    v_fma_f32 v75, v75, v27, v27
    v_permlane32_swap_b32 v112, v114
    v_fma_f32 v64, v64, v30, v29
    v_permlane32_swap_b32 v113, v115
    v_rcp_f32 v74, v74
    v_mul_f32 v79, v79, v207
    v_mul_f32 v201, v201, v73
    s_movk_i32 s76, 4096
    buffer_store_dwordx4 v[112:115], v20, s[52:55], s76 offen offset:0 sc1
    v_exp_f32 v78, v78
    v_mul_f32 v205, v205, v237
    v_mul_f32 v66, v210, v210
    v_fma_f32 v76, v76, v27, v27
    v_fma_f32 v65, v65, v30, v29
    v_rcp_f32 v75, v75
    v_mul_f32 v64, v64, v208
    v_mul_f32 v202, v202, v74
    v_exp_f32 v79, v79
    v_cvt_pk_bf16_f32 v116, v200, v201
    v_mul_f32 v206, v206, v238
    v_mul_f32 v67, v211, v211
    v_fma_f32 v77, v77, v27, v27
    v_fma_f32 v66, v66, v30, v29
    v_rcp_f32 v76, v76
    v_mul_f32 v65, v65, v209
    v_mul_f32 v203, v203, v75
    v_exp_f32 v64, v64
    v_mul_f32 v207, v207, v239
    v_mul_f32 v68, v212, v212
    v_fma_f32 v78, v78, v27, v27
    v_fma_f32 v67, v67, v30, v29
    v_rcp_f32 v77, v77
    v_mul_f32 v66, v66, v210
    v_mul_f32 v204, v204, v76
    v_exp_f32 v65, v65
    v_cvt_pk_bf16_f32 v117, v202, v203
    v_mul_f32 v208, v208, v240
    v_mul_f32 v69, v213, v213
    v_fma_f32 v79, v79, v27, v27
    v_fma_f32 v68, v68, v30, v29
    v_rcp_f32 v78, v78
    v_mul_f32 v67, v67, v211
    v_mul_f32 v205, v205, v77
    v_exp_f32 v66, v66
    v_mul_f32 v209, v209, v241
    v_mul_f32 v70, v214, v214
    v_fma_f32 v64, v64, v31, v31
    v_fma_f32 v69, v69, v30, v29
    v_rcp_f32 v79, v79
    v_mul_f32 v68, v68, v212
    v_mul_f32 v206, v206, v78
    v_exp_f32 v67, v67
    v_cvt_pk_bf16_f32 v118, v204, v205
    v_mul_f32 v210, v210, v242
    v_mul_f32 v71, v215, v215
    v_fma_f32 v65, v65, v31, v31
    v_fma_f32 v70, v70, v30, v29
    v_rcp_f32 v64, v64
    v_mul_f32 v69, v69, v213
    v_mul_f32 v207, v207, v79
    v_exp_f32 v68, v68
    v_mul_f32 v211, v211, v243
    v_mul_f32 v72, v216, v216
    v_fma_f32 v66, v66, v31, v31
    v_fma_f32 v71, v71, v30, v29
    v_rcp_f32 v65, v65
    v_mul_f32 v70, v70, v214
    v_mul_f32 v208, v208, v64
    v_exp_f32 v69, v69
    v_cvt_pk_bf16_f32 v119, v206, v207
    v_mul_f32 v212, v212, v244
    v_mul_f32 v73, v217, v217
    v_fma_f32 v67, v67, v31, v31
    v_permlane32_swap_b32 v116, v118
    v_fma_f32 v72, v72, v30, v29
    v_permlane32_swap_b32 v117, v119
    v_rcp_f32 v66, v66
    v_mul_f32 v71, v71, v215
    v_mul_f32 v209, v209, v65
    s_movk_i32 s76, 4096
    buffer_store_dwordx4 v[116:119], v20, s[52:55], s76 offen offset:512 sc1
    v_exp_f32 v70, v70
    v_mul_f32 v213, v213, v245
    v_mul_f32 v74, v218, v218
    v_fma_f32 v68, v68, v31, v31
    v_fma_f32 v73, v73, v30, v29
    v_rcp_f32 v67, v67
    v_mul_f32 v72, v72, v216
    v_mul_f32 v210, v210, v66
    v_exp_f32 v71, v71
    v_cvt_pk_bf16_f32 v120, v208, v209
    v_mul_f32 v214, v214, v246
    v_mul_f32 v75, v219, v219
    v_fma_f32 v69, v69, v31, v31
    v_fma_f32 v74, v74, v30, v29
    v_rcp_f32 v68, v68
    v_mul_f32 v73, v73, v217
    v_mul_f32 v211, v211, v67
    v_exp_f32 v72, v72
    v_mul_f32 v215, v215, v247
    v_mul_f32 v76, v220, v220
    v_fma_f32 v70, v70, v31, v31
    v_fma_f32 v75, v75, v30, v29
    v_rcp_f32 v69, v69
    v_mul_f32 v74, v74, v218
    v_mul_f32 v212, v212, v68
    v_exp_f32 v73, v73
    v_cvt_pk_bf16_f32 v121, v210, v211
    v_mul_f32 v216, v216, v248
    v_mul_f32 v77, v221, v221
    v_fma_f32 v71, v71, v31, v31
    v_fma_f32 v76, v76, v30, v29
    v_rcp_f32 v70, v70
    v_mul_f32 v75, v75, v219
    v_mul_f32 v213, v213, v69
    v_exp_f32 v74, v74
    v_mul_f32 v217, v217, v249
    v_mul_f32 v78, v222, v222
    v_fma_f32 v72, v72, v31, v31
    v_fma_f32 v77, v77, v30, v29
    v_rcp_f32 v71, v71
    v_mul_f32 v76, v76, v220
    v_mul_f32 v214, v214, v70
    v_exp_f32 v75, v75
    v_cvt_pk_bf16_f32 v122, v212, v213
    v_mul_f32 v218, v218, v250
    v_mul_f32 v79, v223, v223
    v_fma_f32 v73, v73, v31, v31
    s_waitcnt vmcnt(2)
    s_mov_b64 exec, 1
    buffer_store_dword v22, v21, s[52:55], 0 offen offset:0 sc1
    s_mov_b64 exec, -1
    v_fma_f32 v78, v78, v30, v29
    v_rcp_f32 v72, v72
    v_mul_f32 v77, v77, v221
    v_mul_f32 v215, v215, v71
    v_exp_f32 v76, v76
    v_mul_f32 v219, v219, v251
    v_fma_f32 v74, v74, v31, v31
    v_fma_f32 v79, v79, v30, v29
    v_rcp_f32 v73, v73
    v_mul_f32 v78, v78, v222
    v_mul_f32 v216, v216, v72
    v_exp_f32 v77, v77
    v_cvt_pk_bf16_f32 v123, v214, v215
    v_mul_f32 v220, v220, v252
    v_fma_f32 v75, v75, v31, v31
    v_permlane32_swap_b32 v120, v122
    v_permlane32_swap_b32 v121, v123
    v_rcp_f32 v74, v74
    v_mul_f32 v79, v79, v223
    v_mul_f32 v217, v217, v73
    s_movk_i32 s76, 4096
    buffer_store_dwordx4 v[120:123], v20, s[52:55], s76 offen offset:2048 sc1
    v_exp_f32 v78, v78
    v_mul_f32 v221, v221, v253
    v_fma_f32 v76, v76, v31, v31
    v_rcp_f32 v75, v75
    v_mul_f32 v218, v218, v74
    v_exp_f32 v79, v79
    v_cvt_pk_bf16_f32 v124, v216, v217
    v_mul_f32 v222, v222, v254
    v_fma_f32 v77, v77, v31, v31
    v_rcp_f32 v76, v76
    v_mul_f32 v219, v219, v75
    v_mul_f32 v223, v223, v255
    v_fma_f32 v78, v78, v31, v31
    v_rcp_f32 v77, v77
    v_mul_f32 v220, v220, v76
    v_cvt_pk_bf16_f32 v125, v218, v219
    v_fma_f32 v79, v79, v31, v31
    v_rcp_f32 v78, v78
    v_mul_f32 v221, v221, v77
    v_rcp_f32 v79, v79
    v_mul_f32 v222, v222, v78
    v_cvt_pk_bf16_f32 v126, v220, v221
    v_mul_f32 v223, v223, v79
    v_cvt_pk_bf16_f32 v127, v222, v223
    v_permlane32_swap_b32 v124, v126
    s_nop 0
    v_permlane32_swap_b32 v125, v127
    s_movk_i32 s76, 4096
    buffer_store_dwordx4 v[124:127], v20, s[52:55], s76 offen offset:2560 sc1
    ds_read_b64_tr_b16 v[80:81], v4 offset:32768
    ds_read_b64_tr_b16 v[82:83], v4 offset:33280
    ds_read_b64_tr_b16 v[84:85], v4 offset:32776
    ds_read_b64_tr_b16 v[86:87], v4 offset:33288
    ds_read_b64_tr_b16 v[88:89], v5 offset:32768
    ds_read_b64_tr_b16 v[90:91], v5 offset:33280
    ds_read_b64_tr_b16 v[92:93], v5 offset:32776
    ds_read_b64_tr_b16 v[94:95], v5 offset:33288
    ds_read_b64_tr_b16 v[96:97], v4 offset:49152
    ds_read_b64_tr_b16 v[98:99], v4 offset:49664
    ds_read_b64_tr_b16 v[100:101], v4 offset:49160
    ds_read_b64_tr_b16 v[102:103], v4 offset:49672
    ds_read_b64_tr_b16 v[104:105], v5 offset:49152
    ds_read_b64_tr_b16 v[106:107], v5 offset:49664
    ds_read_b64_tr_b16 v[108:109], v5 offset:49160
    ds_read_b64_tr_b16 v[110:111], v5 offset:49672
    ds_read_b64_tr_b16 v[32:33], v6 offset:16384
    ds_read_b64_tr_b16 v[34:35], v6 offset:16896
    ds_read_b64_tr_b16 v[36:37], v6 offset:16392
    ds_read_b64_tr_b16 v[38:39], v6 offset:16904
    ds_read_b64_tr_b16 v[40:41], v7 offset:16384
    ds_read_b64_tr_b16 v[42:43], v7 offset:16896
    ds_read_b64_tr_b16 v[44:45], v7 offset:16392
    ds_read_b64_tr_b16 v[46:47], v7 offset:16904
    ds_read_b64_tr_b16 v[48:49], v4 offset:0
    ds_read_b64_tr_b16 v[50:51], v4 offset:512
    ds_read_b64_tr_b16 v[52:53], v4 offset:8
    ds_read_b64_tr_b16 v[54:55], v4 offset:520
    ds_read_b64_tr_b16 v[56:57], v5 offset:0
    ds_read_b64_tr_b16 v[58:59], v5 offset:512
    ds_read_b64_tr_b16 v[60:61], v5 offset:8
    ds_read_b64_tr_b16 v[62:63], v5 offset:520
    ds_read_b64_tr_b16 v[160:161], v4 offset:16384
    ds_read_b64_tr_b16 v[162:163], v4 offset:16896
    ds_read_b64_tr_b16 v[164:165], v4 offset:16392
    ds_read_b64_tr_b16 v[166:167], v4 offset:16904
    ds_read_b64_tr_b16 v[168:169], v5 offset:16384
    ds_read_b64_tr_b16 v[170:171], v5 offset:16896
    ds_read_b64_tr_b16 v[172:173], v5 offset:16392
    ds_read_b64_tr_b16 v[174:175], v5 offset:16904
    ds_read_b64_tr_b16 v[128:129], v6 offset:0
    ds_read_b64_tr_b16 v[130:131], v6 offset:512
    ds_read_b64_tr_b16 v[132:133], v6 offset:8
    ds_read_b64_tr_b16 v[134:135], v6 offset:520
    ds_read_b64_tr_b16 v[136:137], v7 offset:0
    ds_read_b64_tr_b16 v[138:139], v7 offset:512
    ds_read_b64_tr_b16 v[140:141], v7 offset:8
    ds_read_b64_tr_b16 v[142:143], v7 offset:520
    s_mul_i32 s77, s68, 14
    s_mul_i32 s76, s73, 56
    s_add_u32 s76, s76, s77
    s_lshl_b32 s76, s76, 12
    s_add_u32 s77, s68, 0
    s_and_b32 s77, s77, 3
    s_lshl_b32 s77, s77, 10
    s_add_u32 s77, s77, s76
    v_lshl_add_u32 v9, v1, 4, s77
    s_add_u32 s77, s68, 1
    s_and_b32 s77, s77, 3
    s_lshl_b32 s77, s77, 10
    s_add_u32 s77, s77, s76
    v_lshl_add_u32 v3, v1, 4, s77
    s_add_u32 s77, s68, 2
    s_and_b32 s77, s77, 3
    s_lshl_b32 s77, s77, 10
    s_add_u32 s77, s77, s76
    v_lshl_add_u32 v0, v1, 4, s77
    s_add_u32 s77, s68, 3
    s_and_b32 s77, s77, 3
    s_lshl_b32 s77, s77, 10
    s_add_u32 s77, s77, s76
    v_lshl_add_u32 v10, v1, 4, s77
    v_and_b32 v17, 15, v1
    v_lshrrev_b32 v13, 4, v1
    s_lshl_b32 s76, s73, 6
    s_lshl_b32 s77, s68, 4
    s_add_u32 s76, s76, s77
    v_add_u32 v18, s76, v17
    v_mul_u32_u24 v18, 896, v18
    v_lshl_add_u32 v18, v13, 5, v18
    s_lshl_b32 s76, s74, 7
    v_add_u32 v18, s76, v18
    buffer_load_dwordx4 v[24:27], v18, s[40:43], 0 offen
    buffer_load_dwordx4 v[28:31], v18, s[40:43], 0 offen offset:16
    v_mul_u32_u24 v16, 4352, v13
    v_lshrrev_b32 v13, 2, v17
    v_lshl_add_u32 v16, v13, 7, v16
    v_and_b32 v13, 1, v17
    v_lshl_add_u32 v16, v13, 3, v16
    v_bfe_u32 v13, v17, 1, 1
    v_lshl_add_u32 v16, v13, 6, v16
    s_add_u32 s77, s77, 98304
    v_add_u32 v16, s77, v16
    v_lshl_add_u32 v19, v1, 4, s80
    v_mov_b32 v13, 1
    ds_write_b8 v12, v13 offset:68
    s_waitcnt vmcnt(2)
    s_mov_b64 exec, 1
    buffer_store_dword v22, v21, s[52:55], 0 offen offset:4 sc1
    s_mov_b64 exec, -1
    s_setprio 0
    s_waitcnt lgkmcnt(0)
    s_add_u32 m0, s80, 32768
    s_mov_b32 s81, 344064
    buffer_load_dwordx4 v2, s[56:59], s81 offen lds
    s_add_u32 m0, s80, 33792
    s_mov_b32 s81, 351232
    buffer_load_dwordx4 v2, s[56:59], s81 offen lds
    s_add_u32 m0, s80, 34816
    s_mov_b32 s81, 358400
    buffer_load_dwordx4 v2, s[56:59], s81 offen lds
    s_add_u32 m0, s80, 35840
    s_mov_b32 s81, 365568
    buffer_load_dwordx4 v2, s[56:59], s81 offen lds
    s_add_u32 m0, s80, 49152
    s_mov_b32 s81, 28672
    buffer_load_dwordx4 v2, s[56:59], s81 offen lds
    s_add_u32 m0, s80, 50176
    s_mov_b32 s81, 35840
    buffer_load_dwordx4 v2, s[56:59], s81 offen lds
    s_add_u32 m0, s80, 51200
    s_mov_b32 s81, 43008
    buffer_load_dwordx4 v2, s[56:59], s81 offen lds
    s_add_u32 m0, s80, 52224
    s_mov_b32 s81, 50176
    buffer_load_dwordx4 v2, s[56:59], s81 offen lds
    s_add_u32 m0, s80, 81920
    s_mov_b32 s81, 86016
    buffer_load_dwordx4 v2, s[56:59], s81 offen lds
    s_add_u32 m0, s80, 82944
    s_mov_b32 s81, 93184
    buffer_load_dwordx4 v2, s[56:59], s81 offen lds
    s_add_u32 m0, s80, 83968
    s_mov_b32 s81, 100352
    buffer_load_dwordx4 v2, s[56:59], s81 offen lds
    s_add_u32 m0, s80, 84992
    s_mov_b32 s81, 107520
    buffer_load_dwordx4 v2, s[56:59], s81 offen lds
    s_sleep 4
    s_mov_b64 exec, 0x3fff
    buffer_load_dword v14, v8, s[52:55], 0 offen sc1
    s_mov_b64 exec, -1
    s_waitcnt vmcnt(0)
    v_cmp_ne_u32 vcc, s84, v14
    s_nop 0
    s_and_b32 s76, vcc_lo, 0x1555
    s_cbranch_scc1 HS_10
HJ_9:
    s_andn2_b32 s37, 0x2aaa, vcc_lo
    s_mov_b32 s81, 0
    buffer_load_dwordx4 v[64:67], v9, s[52:55], s81 offen
    buffer_load_dwordx4 v[68:71], v3, s[52:55], s81 offen
    buffer_load_dwordx4 v[72:75], v0, s[52:55], s81 offen
    buffer_load_dwordx4 v[76:79], v10, s[52:55], s81 offen
    s_mov_b32 s81, 8192
    buffer_load_dwordx4 v[112:115], v9, s[52:55], s81 offen
    buffer_load_dwordx4 v[116:119], v3, s[52:55], s81 offen
    buffer_load_dwordx4 v[120:123], v0, s[52:55], s81 offen
    buffer_load_dwordx4 v[124:127], v10, s[52:55], s81 offen
    s_mov_b32 s81, 16384
    buffer_load_dwordx4 v[176:179], v9, s[52:55], s81 offen
    buffer_load_dwordx4 v[180:183], v3, s[52:55], s81 offen
    buffer_load_dwordx4 v[184:187], v0, s[52:55], s81 offen
    buffer_load_dwordx4 v[188:191], v10, s[52:55], s81 offen
    s_mov_b32 s81, 24576
    buffer_load_dwordx4 v[144:147], v9, s[52:55], s81 offen
    buffer_load_dwordx4 v[148:151], v3, s[52:55], s81 offen
    buffer_load_dwordx4 v[152:155], v0, s[52:55], s81 offen
    buffer_load_dwordx4 v[156:159], v10, s[52:55], s81 offen
    s_mov_b32 s75, 0
    s_mov_b32 s18, 65536
    s_mov_b32 s17, 0
    s_mov_b32 s22, 49152
    s_mov_b32 s23, 81920
    s_mov_b32 s24, 1
    s_mov_b32 s25, 16385
    s_mov_b32 s26, 65537
    s_mul_i32 s76, s72, 4864
    s_add_u32 s76, s76, s80
    s_add_u32 s27, s76, 115714
    s_add_u32 s28, s27, 4096
    s_add_u32 s76, s68, 158208
    v_mov_b32 v15, s76
    s_sub_u32 s77, s68, 1
    s_and_b32 s77, s77, 3
    s_lshl_b32 s77, s77, 12
    v_lshl_add_u32 v20, v1, 4, s77
    s_sub_u32 s77, s68, 2
    s_and_b32 s77, s77, 3
    s_lshl_b32 s77, s77, 12
    v_lshl_add_u32 v21, v1, 4, s77
    s_sub_u32 s77, s68, 3
    s_and_b32 s77, s77, 3
    s_lshl_b32 s77, s77, 12
    v_lshl_add_u32 v22, v1, 4, s77
    s_waitcnt vmcnt(15)
    v_mfma_f32_16x16x32_bf16 v[192:195], v[80:83], v[64:67], 0
    v_mfma_f32_16x16x32_bf16 v[208:211], v[84:87], v[64:67], 0
    v_mfma_f32_16x16x32_bf16 v[224:227], v[88:91], v[64:67], 0
    v_mfma_f32_16x16x32_bf16 v[240:243], v[92:95], v[64:67], 0
    s_waitcnt vmcnt(14)
    v_mfma_f32_16x16x32_bf16 v[196:199], v[80:83], v[68:71], 0
    v_mfma_f32_16x16x32_bf16 v[212:215], v[84:87], v[68:71], 0
    v_mfma_f32_16x16x32_bf16 v[228:231], v[88:91], v[68:71], 0
    v_mfma_f32_16x16x32_bf16 v[244:247], v[92:95], v[68:71], 0
    s_waitcnt vmcnt(13)
    v_mfma_f32_16x16x32_bf16 v[200:203], v[80:83], v[72:75], 0
    v_mfma_f32_16x16x32_bf16 v[216:219], v[84:87], v[72:75], 0
    v_mfma_f32_16x16x32_bf16 v[232:235], v[88:91], v[72:75], 0
    v_mfma_f32_16x16x32_bf16 v[248:251], v[92:95], v[72:75], 0
    s_waitcnt vmcnt(12)
    v_mfma_f32_16x16x32_bf16 v[204:207], v[80:83], v[76:79], 0
    v_mfma_f32_16x16x32_bf16 v[220:223], v[84:87], v[76:79], 0
    v_mfma_f32_16x16x32_bf16 v[236:239], v[88:91], v[76:79], 0
    v_mfma_f32_16x16x32_bf16 v[252:255], v[92:95], v[76:79], 0
    s_waitcnt vmcnt(11)
    v_mfma_f32_16x16x32_bf16 v[192:195], v[96:99], v[112:115], v[192:195]
    s_cmp_eq_u32 s37, 0x2aaa
    s_cbranch_scc1 DP_12
    s_mov_b64 exec, 0x3fff
    buffer_load_dword v23, v8, s[52:55], 0 offen sc1
    s_mov_b64 exec, -1
DP_12:
    v_mfma_f32_16x16x32_bf16 v[208:211], v[100:103], v[112:115], v[208:211]
    s_mov_b32 s81, 32768
    buffer_load_dwordx4 v[64:67], v9, s[52:55], s81 offen
    buffer_load_dwordx4 v[68:71], v3, s[52:55], s81 offen
    v_mfma_f32_16x16x32_bf16 v[224:227], v[104:107], v[112:115], v[224:227]
    buffer_load_dwordx4 v[72:75], v0, s[52:55], s81 offen
    buffer_load_dwordx4 v[76:79], v10, s[52:55], s81 offen
    v_mfma_f32_16x16x32_bf16 v[240:243], v[108:111], v[112:115], v[240:243]
    s_waitcnt vmcnt(14)
    v_mfma_f32_16x16x32_bf16 v[196:199], v[96:99], v[116:119], v[196:199]
    v_mfma_f32_16x16x32_bf16 v[212:215], v[100:103], v[116:119], v[212:215]
    v_mfma_f32_16x16x32_bf16 v[228:231], v[104:107], v[116:119], v[228:231]
    v_mfma_f32_16x16x32_bf16 v[244:247], v[108:111], v[116:119], v[244:247]
    s_waitcnt vmcnt(13)
    v_mfma_f32_16x16x32_bf16 v[200:203], v[96:99], v[120:123], v[200:203]
    v_mfma_f32_16x16x32_bf16 v[216:219], v[100:103], v[120:123], v[216:219]
    v_mfma_f32_16x16x32_bf16 v[232:235], v[104:107], v[120:123], v[232:235]
    v_mfma_f32_16x16x32_bf16 v[248:251], v[108:111], v[120:123], v[248:251]
    s_waitcnt vmcnt(12)
    v_mfma_f32_16x16x32_bf16 v[204:207], v[96:99], v[124:127], v[204:207]
    v_mfma_f32_16x16x32_bf16 v[220:223], v[100:103], v[124:127], v[220:223]
    v_mfma_f32_16x16x32_bf16 v[236:239], v[104:107], v[124:127], v[236:239]
    v_mfma_f32_16x16x32_bf16 v[252:255], v[108:111], v[124:127], v[252:255]
    s_waitcnt vmcnt(11)
    v_mfma_f32_16x16x32_bf16 v[192:195], v[32:35], v[176:179], v[192:195]
    s_mov_b32 s81, 40960
    buffer_load_dwordx4 v[80:83], v9, s[52:55], s81 offen
    buffer_load_dwordx4 v[84:87], v3, s[52:55], s81 offen
    v_mfma_f32_16x16x32_bf16 v[208:211], v[36:39], v[176:179], v[208:211]
    buffer_load_dwordx4 v[88:91], v0, s[52:55], s81 offen
    buffer_load_dwordx4 v[92:95], v10, s[52:55], s81 offen
    v_mfma_f32_16x16x32_bf16 v[224:227], v[40:43], v[176:179], v[224:227]
    v_mfma_f32_16x16x32_bf16 v[240:243], v[44:47], v[176:179], v[240:243]
    s_waitcnt vmcnt(14)
    v_mfma_f32_16x16x32_bf16 v[196:199], v[32:35], v[180:183], v[196:199]
    v_mfma_f32_16x16x32_bf16 v[212:215], v[36:39], v[180:183], v[212:215]
    v_mfma_f32_16x16x32_bf16 v[228:231], v[40:43], v[180:183], v[228:231]
    v_mfma_f32_16x16x32_bf16 v[244:247], v[44:47], v[180:183], v[244:247]
    s_waitcnt vmcnt(13)
    v_mfma_f32_16x16x32_bf16 v[200:203], v[32:35], v[184:187], v[200:203]
    v_mfma_f32_16x16x32_bf16 v[216:219], v[36:39], v[184:187], v[216:219]
    v_mfma_f32_16x16x32_bf16 v[232:235], v[40:43], v[184:187], v[232:235]
    v_mfma_f32_16x16x32_bf16 v[248:251], v[44:47], v[184:187], v[248:251]
    s_waitcnt vmcnt(12)
    v_mfma_f32_16x16x32_bf16 v[204:207], v[32:35], v[188:191], v[204:207]
    v_mfma_f32_16x16x32_bf16 v[220:223], v[36:39], v[188:191], v[220:223]
    v_mfma_f32_16x16x32_bf16 v[236:239], v[40:43], v[188:191], v[236:239]
    v_mfma_f32_16x16x32_bf16 v[252:255], v[44:47], v[188:191], v[252:255]
    s_waitcnt vmcnt(11)
    v_mfma_f32_16x16x32_bf16 v[192:195], v[48:51], v[144:147], v[192:195]
    s_mov_b32 s81, 49152
    buffer_load_dwordx4 v[112:115], v9, s[52:55], s81 offen
    buffer_load_dwordx4 v[116:119], v3, s[52:55], s81 offen
    v_mfma_f32_16x16x32_bf16 v[208:211], v[52:55], v[144:147], v[208:211]
    buffer_load_dwordx4 v[120:123], v0, s[52:55], s81 offen
    buffer_load_dwordx4 v[124:127], v10, s[52:55], s81 offen
    v_mfma_f32_16x16x32_bf16 v[224:227], v[56:59], v[144:147], v[224:227]
    v_mfma_f32_16x16x32_bf16 v[240:243], v[60:63], v[144:147], v[240:243]
    s_waitcnt vmcnt(14)
    v_mfma_f32_16x16x32_bf16 v[196:199], v[48:51], v[148:151], v[196:199]
    v_mfma_f32_16x16x32_bf16 v[212:215], v[52:55], v[148:151], v[212:215]
    v_mfma_f32_16x16x32_bf16 v[228:231], v[56:59], v[148:151], v[228:231]
    v_mfma_f32_16x16x32_bf16 v[244:247], v[60:63], v[148:151], v[244:247]
    s_waitcnt vmcnt(13)
    v_mfma_f32_16x16x32_bf16 v[200:203], v[48:51], v[152:155], v[200:203]
    v_mfma_f32_16x16x32_bf16 v[216:219], v[52:55], v[152:155], v[216:219]
    v_mfma_f32_16x16x32_bf16 v[232:235], v[56:59], v[152:155], v[232:235]
    v_mfma_f32_16x16x32_bf16 v[248:251], v[60:63], v[152:155], v[248:251]
    s_waitcnt vmcnt(12)
    v_mfma_f32_16x16x32_bf16 v[204:207], v[48:51], v[156:159], v[204:207]
    v_mfma_f32_16x16x32_bf16 v[220:223], v[52:55], v[156:159], v[220:223]
    v_mfma_f32_16x16x32_bf16 v[236:239], v[56:59], v[156:159], v[236:239]
    v_mfma_f32_16x16x32_bf16 v[252:255], v[60:63], v[156:159], v[252:255]
    s_waitcnt vmcnt(11)
    v_mfma_f32_16x16x32_bf16 v[192:195], v[160:163], v[64:67], v[192:195]
    s_getpc_b64 s[20:21]
    s_andn2_b32 s76, s37, s75
    s_cbranch_scc0 K_DS
    s_ff1_i32_b32 s77, s76
    v_mfma_f32_16x16x32_bf16 v[208:211], v[164:167], v[64:67], v[208:211]
    s_lshr_b32 m0, s77, 1
    s_lshl_b32 s81, s77, 12
    s_bitset1_b32 s75, s77
    s_movrels_b32 s8, s22
    v_mfma_f32_16x16x32_bf16 v[224:227], v[168:171], v[64:67], v[224:227]
    buffer_load_dwordx4 v[96:99], v9, s[52:55], s81 offen
    buffer_load_dwordx4 v[100:103], v3, s[52:55], s81 offen
    v_mfma_f32_16x16x32_bf16 v[240:243], v[172:175], v[64:67], v[240:243]
    buffer_load_dwordx4 v[104:107], v0, s[52:55], s81 offen
    buffer_load_dwordx4 v[108:111], v10, s[52:55], s81 offen
    s_waitcnt vmcnt(14)
    v_mfma_f32_16x16x32_bf16 v[196:199], v[160:163], v[68:71], v[196:199]
    v_mfma_f32_16x16x32_bf16 v[212:215], v[164:167], v[68:71], v[212:215]
    v_mfma_f32_16x16x32_bf16 v[228:231], v[168:171], v[68:71], v[228:231]
    v_mfma_f32_16x16x32_bf16 v[244:247], v[172:175], v[68:71], v[244:247]
    s_waitcnt vmcnt(13)
    v_mfma_f32_16x16x32_bf16 v[200:203], v[160:163], v[72:75], v[200:203]
    v_mfma_f32_16x16x32_bf16 v[216:219], v[164:167], v[72:75], v[216:219]
    v_mfma_f32_16x16x32_bf16 v[232:235], v[168:171], v[72:75], v[232:235]
    v_mfma_f32_16x16x32_bf16 v[248:251], v[172:175], v[72:75], v[248:251]
    s_waitcnt vmcnt(12)
    v_mfma_f32_16x16x32_bf16 v[204:207], v[160:163], v[76:79], v[204:207]
    v_mfma_f32_16x16x32_bf16 v[220:223], v[164:167], v[76:79], v[220:223]
    v_mfma_f32_16x16x32_bf16 v[236:239], v[168:171], v[76:79], v[236:239]
    v_mfma_f32_16x16x32_bf16 v[252:255], v[172:175], v[76:79], v[252:255]
    s_waitcnt vmcnt(11)
    v_mfma_f32_16x16x32_bf16 v[192:195], v[128:131], v[80:83], v[192:195]
    v_cmp_eq_u32 vcc, s84, v23
    s_nop 0
    s_and_b32 s76, vcc_lo, 0x2aaa
    s_or_b32 s37, s37, s76
    v_mfma_f32_16x16x32_bf16 v[208:211], v[132:135], v[80:83], v[208:211]
    s_cmp_eq_u32 s37, 0x2aaa
    s_cbranch_scc1 DP_13
    s_mov_b64 exec, 0x3fff
    buffer_load_dword v17, v8, s[52:55], 0 offen sc1
    s_mov_b64 exec, -1
DP_13:
    v_mfma_f32_16x16x32_bf16 v[224:227], v[136:139], v[80:83], v[224:227]
    s_getpc_b64 s[20:21]
    s_andn2_b32 s76, s37, s75
    s_cbranch_scc0 K_DS
    s_ff1_i32_b32 s77, s76
    v_mfma_f32_16x16x32_bf16 v[240:243], v[140:143], v[80:83], v[240:243]
    s_lshr_b32 m0, s77, 1
    s_lshl_b32 s81, s77, 12
    s_bitset1_b32 s75, s77
    s_movrels_b32 s9, s22
    s_waitcnt vmcnt(10)
    v_mfma_f32_16x16x32_bf16 v[196:199], v[128:131], v[84:87], v[196:199]
    buffer_load_dwordx4 v[176:179], v9, s[52:55], s81 offen
    buffer_load_dwordx4 v[180:183], v3, s[52:55], s81 offen
    v_mfma_f32_16x16x32_bf16 v[212:215], v[132:135], v[84:87], v[212:215]
    buffer_load_dwordx4 v[184:187], v0, s[52:55], s81 offen
    buffer_load_dwordx4 v[188:191], v10, s[52:55], s81 offen
    v_mfma_f32_16x16x32_bf16 v[228:231], v[136:139], v[84:87], v[228:231]
    ds_read_b64_tr_b16 v[32:33], v4 offset:32768
    ds_read_b64_tr_b16 v[34:35], v4 offset:33280
    v_mfma_f32_16x16x32_bf16 v[244:247], v[140:143], v[84:87], v[244:247]
    ds_read_b64_tr_b16 v[36:37], v4 offset:32776
    ds_read_b64_tr_b16 v[38:39], v4 offset:33288
    s_waitcnt vmcnt(13)
    v_mfma_f32_16x16x32_bf16 v[200:203], v[128:131], v[88:91], v[200:203]
    ds_read_b64_tr_b16 v[40:41], v5 offset:32768
    ds_read_b64_tr_b16 v[42:43], v5 offset:33280
    v_mfma_f32_16x16x32_bf16 v[216:219], v[132:135], v[88:91], v[216:219]
    ds_read_b64_tr_b16 v[44:45], v5 offset:32776
    ds_read_b64_tr_b16 v[46:47], v5 offset:33288
    v_mfma_f32_16x16x32_bf16 v[232:235], v[136:139], v[88:91], v[232:235]
    v_mfma_f32_16x16x32_bf16 v[248:251], v[140:143], v[88:91], v[248:251]
    s_waitcnt vmcnt(12)
    v_mfma_f32_16x16x32_bf16 v[204:207], v[128:131], v[92:95], v[204:207]
    v_mfma_f32_16x16x32_bf16 v[220:223], v[132:135], v[92:95], v[220:223]
    v_mfma_f32_16x16x32_bf16 v[236:239], v[136:139], v[92:95], v[236:239]
    v_mfma_f32_16x16x32_bf16 v[252:255], v[140:143], v[92:95], v[252:255]
    s_waitcnt lgkmcnt(0)
    s_waitcnt vmcnt(11)
    v_mfma_f32_16x16x32_bf16 v[192:195], v[32:35], v[112:115], v[192:195]
    s_getpc_b64 s[20:21]
    s_andn2_b32 s76, s37, s75
    s_cbranch_scc0 K_DS
    s_ff1_i32_b32 s77, s76
    v_mfma_f32_16x16x32_bf16 v[208:211], v[36:39], v[112:115], v[208:211]
    s_lshr_b32 m0, s77, 1
    s_lshl_b32 s81, s77, 12
    s_bitset1_b32 s75, s77
    s_movrels_b32 s10, s22
    v_mfma_f32_16x16x32_bf16 v[224:227], v[40:43], v[112:115], v[224:227]
    buffer_load_dwordx4 v[144:147], v9, s[52:55], s81 offen
    buffer_load_dwordx4 v[148:151], v3, s[52:55], s81 offen
    v_mfma_f32_16x16x32_bf16 v[240:243], v[44:47], v[112:115], v[240:243]
    buffer_load_dwordx4 v[152:155], v0, s[52:55], s81 offen
    buffer_load_dwordx4 v[156:159], v10, s[52:55], s81 offen
    s_waitcnt vmcnt(14)
    v_mfma_f32_16x16x32_bf16 v[196:199], v[32:35], v[116:119], v[196:199]
    s_and_b32 s78, s8, 3
    s_getpc_b64 s[20:21]
    s_cmp_gt_u32 s78, s17
    s_cbranch_scc1 K_WS
    v_mfma_f32_16x16x32_bf16 v[212:215], v[36:39], v[116:119], v[212:215]
    s_sub_u32 s8, s8, s78
    v_add_u32 v6, s8, v4
    v_add_u32 v7, s8, v5
    v_mfma_f32_16x16x32_bf16 v[228:231], v[40:43], v[116:119], v[228:231]
    ds_read_b64_tr_b16 v[48:49], v6 offset:0
    ds_read_b64_tr_b16 v[50:51], v6 offset:512
    v_mfma_f32_16x16x32_bf16 v[244:247], v[44:47], v[116:119], v[244:247]
    ds_read_b64_tr_b16 v[52:53], v6 offset:8
    ds_read_b64_tr_b16 v[54:55], v6 offset:520
    s_waitcnt vmcnt(13)
    v_mfma_f32_16x16x32_bf16 v[200:203], v[32:35], v[120:123], v[200:203]
    ds_read_b64_tr_b16 v[56:57], v7 offset:0
    ds_read_b64_tr_b16 v[58:59], v7 offset:512
    v_mfma_f32_16x16x32_bf16 v[216:219], v[36:39], v[120:123], v[216:219]
    ds_read_b64_tr_b16 v[60:61], v7 offset:8
    ds_read_b64_tr_b16 v[62:63], v7 offset:520
    v_mfma_f32_16x16x32_bf16 v[232:235], v[40:43], v[120:123], v[232:235]
    v_mfma_f32_16x16x32_bf16 v[248:251], v[44:47], v[120:123], v[248:251]
    s_waitcnt vmcnt(12)
    v_mfma_f32_16x16x32_bf16 v[204:207], v[32:35], v[124:127], v[204:207]
    v_mfma_f32_16x16x32_bf16 v[220:223], v[36:39], v[124:127], v[220:223]
    v_mfma_f32_16x16x32_bf16 v[236:239], v[40:43], v[124:127], v[236:239]
    v_mfma_f32_16x16x32_bf16 v[252:255], v[44:47], v[124:127], v[252:255]
    s_waitcnt lgkmcnt(0)
    s_waitcnt vmcnt(11)
    v_mfma_f32_16x16x32_bf16 v[192:195], v[48:51], v[96:99], v[192:195]
    s_getpc_b64 s[20:21]
    s_andn2_b32 s76, s37, s75
    s_cbranch_scc0 K_DS
    s_ff1_i32_b32 s77, s76
    v_mfma_f32_16x16x32_bf16 v[208:211], v[52:55], v[96:99], v[208:211]
    s_lshr_b32 m0, s77, 1
    s_lshl_b32 s81, s77, 12
    s_bitset1_b32 s75, s77
    s_movrels_b32 s11, s22
    v_mfma_f32_16x16x32_bf16 v[224:227], v[56:59], v[96:99], v[224:227]
    buffer_load_dwordx4 v[64:67], v9, s[52:55], s81 offen
    buffer_load_dwordx4 v[68:71], v3, s[52:55], s81 offen
    v_mfma_f32_16x16x32_bf16 v[240:243], v[60:63], v[96:99], v[240:243]
    buffer_load_dwordx4 v[72:75], v0, s[52:55], s81 offen
    buffer_load_dwordx4 v[76:79], v10, s[52:55], s81 offen
    s_waitcnt vmcnt(14)
    v_mfma_f32_16x16x32_bf16 v[196:199], v[48:51], v[100:103], v[196:199]
    s_and_b32 s78, s9, 3
    s_getpc_b64 s[20:21]
    s_cmp_gt_u32 s78, s17
    s_cbranch_scc1 K_WS
    v_mfma_f32_16x16x32_bf16 v[212:215], v[52:55], v[100:103], v[212:215]
    s_sub_u32 s9, s9, s78
    v_add_u32 v6, s9, v4
    v_add_u32 v7, s9, v5
    v_mfma_f32_16x16x32_bf16 v[228:231], v[56:59], v[100:103], v[228:231]
    ds_read_b64_tr_b16 v[160:161], v6 offset:0
    ds_read_b64_tr_b16 v[162:163], v6 offset:512
    v_mfma_f32_16x16x32_bf16 v[244:247], v[60:63], v[100:103], v[244:247]
    ds_read_b64_tr_b16 v[164:165], v6 offset:8
    ds_read_b64_tr_b16 v[166:167], v6 offset:520
    s_waitcnt vmcnt(13)
    v_mfma_f32_16x16x32_bf16 v[200:203], v[48:51], v[104:107], v[200:203]
    ds_read_b64_tr_b16 v[168:169], v7 offset:0
    ds_read_b64_tr_b16 v[170:171], v7 offset:512
    v_mfma_f32_16x16x32_bf16 v[216:219], v[52:55], v[104:107], v[216:219]
    ds_read_b64_tr_b16 v[172:173], v7 offset:8
    ds_read_b64_tr_b16 v[174:175], v7 offset:520
    v_mfma_f32_16x16x32_bf16 v[232:235], v[56:59], v[104:107], v[232:235]
    v_mfma_f32_16x16x32_bf16 v[248:251], v[60:63], v[104:107], v[248:251]
    s_waitcnt vmcnt(12)
    v_mfma_f32_16x16x32_bf16 v[204:207], v[48:51], v[108:111], v[204:207]
    v_mfma_f32_16x16x32_bf16 v[220:223], v[52:55], v[108:111], v[220:223]
    v_mfma_f32_16x16x32_bf16 v[236:239], v[56:59], v[108:111], v[236:239]
    v_mfma_f32_16x16x32_bf16 v[252:255], v[60:63], v[108:111], v[252:255]
    s_waitcnt lgkmcnt(0)
    s_waitcnt vmcnt(11)
    v_mfma_f32_16x16x32_bf16 v[192:195], v[160:163], v[176:179], v[192:195]
    s_getpc_b64 s[20:21]
    s_andn2_b32 s76, s37, s75
    s_cbranch_scc0 K_DS
    s_ff1_i32_b32 s77, s76
    v_mfma_f32_16x16x32_bf16 v[208:211], v[164:167], v[176:179], v[208:211]
    s_lshr_b32 m0, s77, 1
    s_lshl_b32 s81, s77, 12
    s_bitset1_b32 s75, s77
    s_movrels_b32 s12, s22
    v_mfma_f32_16x16x32_bf16 v[224:227], v[168:171], v[176:179], v[224:227]
    buffer_load_dwordx4 v[80:83], v9, s[52:55], s81 offen
    buffer_load_dwordx4 v[84:87], v3, s[52:55], s81 offen
    v_mfma_f32_16x16x32_bf16 v[240:243], v[172:175], v[176:179], v[240:243]
    buffer_load_dwordx4 v[88:91], v0, s[52:55], s81 offen
    buffer_load_dwordx4 v[92:95], v10, s[52:55], s81 offen
    s_waitcnt vmcnt(14)
    v_mfma_f32_16x16x32_bf16 v[196:199], v[160:163], v[180:183], v[196:199]
    s_and_b32 s78, s10, 3
    s_getpc_b64 s[20:21]
    s_cmp_gt_u32 s78, s17
    s_cbranch_scc1 K_WS
    v_mfma_f32_16x16x32_bf16 v[212:215], v[164:167], v[180:183], v[212:215]
    s_sub_u32 s10, s10, s78
    v_add_u32 v6, s10, v4
    v_add_u32 v7, s10, v5
    v_mfma_f32_16x16x32_bf16 v[228:231], v[168:171], v[180:183], v[228:231]
    ds_read_b64_tr_b16 v[128:129], v6 offset:0
    ds_read_b64_tr_b16 v[130:131], v6 offset:512
    v_mfma_f32_16x16x32_bf16 v[244:247], v[172:175], v[180:183], v[244:247]
    ds_read_b64_tr_b16 v[132:133], v6 offset:8
    ds_read_b64_tr_b16 v[134:135], v6 offset:520
    s_waitcnt vmcnt(13)
    v_mfma_f32_16x16x32_bf16 v[200:203], v[160:163], v[184:187], v[200:203]
    ds_read_b64_tr_b16 v[136:137], v7 offset:0
    ds_read_b64_tr_b16 v[138:139], v7 offset:512
    v_mfma_f32_16x16x32_bf16 v[216:219], v[164:167], v[184:187], v[216:219]
    ds_read_b64_tr_b16 v[140:141], v7 offset:8
    ds_read_b64_tr_b16 v[142:143], v7 offset:520
    v_mfma_f32_16x16x32_bf16 v[232:235], v[168:171], v[184:187], v[232:235]
    v_mfma_f32_16x16x32_bf16 v[248:251], v[172:175], v[184:187], v[248:251]
    s_waitcnt vmcnt(12)
    v_mfma_f32_16x16x32_bf16 v[204:207], v[160:163], v[188:191], v[204:207]
    v_mfma_f32_16x16x32_bf16 v[220:223], v[164:167], v[188:191], v[220:223]
    v_mfma_f32_16x16x32_bf16 v[236:239], v[168:171], v[188:191], v[236:239]
    v_mfma_f32_16x16x32_bf16 v[252:255], v[172:175], v[188:191], v[252:255]
    s_waitcnt lgkmcnt(0)
    s_waitcnt vmcnt(11)
    v_mfma_f32_16x16x32_bf16 v[192:195], v[128:131], v[144:147], v[192:195]
    v_cmp_eq_u32 vcc, s84, v17
    s_nop 0
    s_and_b32 s76, vcc_lo, 0x2aaa
    s_or_b32 s37, s37, s76
    v_mfma_f32_16x16x32_bf16 v[208:211], v[132:135], v[144:147], v[208:211]
    s_cmp_eq_u32 s37, 0x2aaa
    s_cbranch_scc1 DP_14
    s_mov_b64 exec, 0x3fff
    buffer_load_dword v2, v8, s[52:55], 0 offen sc1
    s_mov_b64 exec, -1
DP_14:
    v_mfma_f32_16x16x32_bf16 v[224:227], v[136:139], v[144:147], v[224:227]
    s_getpc_b64 s[20:21]
    s_andn2_b32 s76, s37, s75
    s_cbranch_scc0 K_DS
    s_ff1_i32_b32 s77, s76
    v_mfma_f32_16x16x32_bf16 v[240:243], v[140:143], v[144:147], v[240:243]
    s_lshr_b32 m0, s77, 1
    s_lshl_b32 s81, s77, 12
    s_bitset1_b32 s75, s77
    s_movrels_b32 s13, s22
    s_waitcnt vmcnt(10)
    v_mfma_f32_16x16x32_bf16 v[196:199], v[128:131], v[148:151], v[196:199]
    buffer_load_dwordx4 v[112:115], v9, s[52:55], s81 offen
    buffer_load_dwordx4 v[116:119], v3, s[52:55], s81 offen
    v_mfma_f32_16x16x32_bf16 v[212:215], v[132:135], v[148:151], v[212:215]
    buffer_load_dwordx4 v[120:123], v0, s[52:55], s81 offen
    buffer_load_dwordx4 v[124:127], v10, s[52:55], s81 offen
    v_mfma_f32_16x16x32_bf16 v[228:231], v[136:139], v[148:151], v[228:231]
    s_and_b32 s78, s11, 3
    s_getpc_b64 s[20:21]
    s_cmp_gt_u32 s78, s17
    s_cbranch_scc1 K_WS
    v_mfma_f32_16x16x32_bf16 v[244:247], v[140:143], v[148:151], v[244:247]
    s_sub_u32 s11, s11, s78
    v_add_u32 v6, s11, v4
    v_add_u32 v7, s11, v5
    s_waitcnt vmcnt(13)
    v_mfma_f32_16x16x32_bf16 v[200:203], v[128:131], v[152:155], v[200:203]
    ds_read_b64_tr_b16 v[32:33], v6 offset:0
    ds_read_b64_tr_b16 v[34:35], v6 offset:512
    v_mfma_f32_16x16x32_bf16 v[216:219], v[132:135], v[152:155], v[216:219]
    ds_read_b64_tr_b16 v[36:37], v6 offset:8
    ds_read_b64_tr_b16 v[38:39], v6 offset:520
    v_mfma_f32_16x16x32_bf16 v[232:235], v[136:139], v[152:155], v[232:235]
    ds_read_b64_tr_b16 v[40:41], v7 offset:0
    ds_read_b64_tr_b16 v[42:43], v7 offset:512
    v_mfma_f32_16x16x32_bf16 v[248:251], v[140:143], v[152:155], v[248:251]
    ds_read_b64_tr_b16 v[44:45], v7 offset:8
    ds_read_b64_tr_b16 v[46:47], v7 offset:520
    s_waitcnt vmcnt(12)
    v_mfma_f32_16x16x32_bf16 v[204:207], v[128:131], v[156:159], v[204:207]
    v_mfma_f32_16x16x32_bf16 v[220:223], v[132:135], v[156:159], v[220:223]
    v_mfma_f32_16x16x32_bf16 v[236:239], v[136:139], v[156:159], v[236:239]
    v_mfma_f32_16x16x32_bf16 v[252:255], v[140:143], v[156:159], v[252:255]
    s_waitcnt lgkmcnt(0)
    s_waitcnt vmcnt(11)
    v_mfma_f32_16x16x32_bf16 v[192:195], v[32:35], v[64:67], v[192:195]
    s_getpc_b64 s[20:21]
    s_andn2_b32 s76, s37, s75
    s_cbranch_scc0 K_DS
    s_ff1_i32_b32 s77, s76
    v_mfma_f32_16x16x32_bf16 v[208:211], v[36:39], v[64:67], v[208:211]
    s_lshr_b32 m0, s77, 1
    s_lshl_b32 s81, s77, 12
    s_bitset1_b32 s75, s77
    s_movrels_b32 s14, s22
    v_mfma_f32_16x16x32_bf16 v[224:227], v[40:43], v[64:67], v[224:227]
    buffer_load_dwordx4 v[100:103], v3, s[52:55], s81 offen
    buffer_load_dwordx4 v[104:107], v0, s[52:55], s81 offen
    v_mfma_f32_16x16x32_bf16 v[240:243], v[44:47], v[64:67], v[240:243]
    buffer_load_dwordx4 v[108:111], v10, s[52:55], s81 offen
    buffer_load_dwordx4 v[96:99], v9, s[52:55], s81 offen
    s_waitcnt vmcnt(14)
    v_mfma_f32_16x16x32_bf16 v[196:199], v[32:35], v[68:71], v[196:199]
    s_and_b32 s78, s12, 3
    s_getpc_b64 s[20:21]
    s_cmp_gt_u32 s78, s17
    s_cbranch_scc1 K_WS
    v_mfma_f32_16x16x32_bf16 v[212:215], v[36:39], v[68:71], v[212:215]
    s_sub_u32 s12, s12, s78
    v_add_u32 v6, s12, v4
    v_add_u32 v7, s12, v5
    v_mfma_f32_16x16x32_bf16 v[228:231], v[40:43], v[68:71], v[228:231]
    ds_read_b64_tr_b16 v[48:49], v6 offset:0
    ds_read_b64_tr_b16 v[50:51], v6 offset:512
    v_mfma_f32_16x16x32_bf16 v[244:247], v[44:47], v[68:71], v[244:247]
    ds_read_b64_tr_b16 v[52:53], v6 offset:8
    ds_read_b64_tr_b16 v[54:55], v6 offset:520
    s_waitcnt vmcnt(13)
    v_mfma_f32_16x16x32_bf16 v[200:203], v[32:35], v[72:75], v[200:203]
    ds_read_b64_tr_b16 v[56:57], v7 offset:0
    ds_read_b64_tr_b16 v[58:59], v7 offset:512
    v_mfma_f32_16x16x32_bf16 v[216:219], v[36:39], v[72:75], v[216:219]
    ds_read_b64_tr_b16 v[60:61], v7 offset:8
    ds_read_b64_tr_b16 v[62:63], v7 offset:520
    v_mfma_f32_16x16x32_bf16 v[232:235], v[40:43], v[72:75], v[232:235]
    v_mfma_f32_16x16x32_bf16 v[248:251], v[44:47], v[72:75], v[248:251]
    s_waitcnt vmcnt(12)
    v_mfma_f32_16x16x32_bf16 v[204:207], v[32:35], v[76:79], v[204:207]
    v_mfma_f32_16x16x32_bf16 v[220:223], v[36:39], v[76:79], v[220:223]
    v_mfma_f32_16x16x32_bf16 v[236:239], v[40:43], v[76:79], v[236:239]
    v_mfma_f32_16x16x32_bf16 v[252:255], v[44:47], v[76:79], v[252:255]
    s_waitcnt lgkmcnt(0)
    s_waitcnt vmcnt(11)
    v_mfma_f32_16x16x32_bf16 v[192:195], v[48:51], v[80:83], v[192:195]
    s_waitcnt vmcnt(8)
    v_cmp_eq_u32 vcc, s84, v2
    s_nop 0
    s_and_b32 s76, vcc_lo, 0x2aaa
    s_or_b32 s37, s37, s76
    s_and_b32 s78, s13, 3
    s_getpc_b64 s[20:21]
    s_cmp_gt_u32 s78, s17
    s_cbranch_scc1 K_WS
    v_mfma_f32_16x16x32_bf16 v[208:211], v[52:55], v[80:83], v[208:211]
    s_sub_u32 s13, s13, s78
    v_add_u32 v6, s13, v4
    v_add_u32 v7, s13, v5
    v_mfma_f32_16x16x32_bf16 v[224:227], v[56:59], v[80:83], v[224:227]
    ds_read_b64_tr_b16 v[176:177], v6 offset:0
    ds_read_b64_tr_b16 v[178:179], v6 offset:512
    v_mfma_f32_16x16x32_bf16 v[240:243], v[60:63], v[80:83], v[240:243]
    ds_read_b64_tr_b16 v[180:181], v6 offset:8
    ds_read_b64_tr_b16 v[182:183], v6 offset:520
    v_mfma_f32_16x16x32_bf16 v[196:199], v[48:51], v[84:87], v[196:199]
    ds_read_b64_tr_b16 v[184:185], v7 offset:0
    ds_read_b64_tr_b16 v[186:187], v7 offset:512
    v_mfma_f32_16x16x32_bf16 v[212:215], v[52:55], v[84:87], v[212:215]
    ds_read_b64_tr_b16 v[188:189], v7 offset:8
    ds_read_b64_tr_b16 v[190:191], v7 offset:520
    v_mfma_f32_16x16x32_bf16 v[228:231], v[56:59], v[84:87], v[228:231]
    v_mfma_f32_16x16x32_bf16 v[244:247], v[60:63], v[84:87], v[244:247]
    v_lshlrev_b32 v160, 16, v24
    v_and_b32 v161, 0xffff0000, v24
    v_mfma_f32_16x16x32_bf16 v[200:203], v[48:51], v[88:91], v[200:203]
    v_lshlrev_b32 v162, 16, v25
    v_and_b32 v163, 0xffff0000, v25
    v_mfma_f32_16x16x32_bf16 v[216:219], v[52:55], v[88:91], v[216:219]
    v_lshlrev_b32 v164, 16, v26
    v_and_b32 v165, 0xffff0000, v26
    v_mfma_f32_16x16x32_bf16 v[232:235], v[56:59], v[88:91], v[232:235]
    v_lshlrev_b32 v166, 16, v27
    v_and_b32 v167, 0xffff0000, v27
    v_mfma_f32_16x16x32_bf16 v[248:251], v[60:63], v[88:91], v[248:251]
    v_lshlrev_b32 v168, 16, v28
    v_and_b32 v169, 0xffff0000, v28
    v_mfma_f32_16x16x32_bf16 v[204:207], v[48:51], v[92:95], v[204:207]
    v_lshlrev_b32 v170, 16, v29
    v_and_b32 v171, 0xffff0000, v29
    v_mfma_f32_16x16x32_bf16 v[220:223], v[52:55], v[92:95], v[220:223]
    v_lshlrev_b32 v172, 16, v30
    v_and_b32 v173, 0xffff0000, v30
    v_mfma_f32_16x16x32_bf16 v[236:239], v[56:59], v[92:95], v[236:239]
    v_lshlrev_b32 v174, 16, v31
    v_and_b32 v175, 0xffff0000, v31
    v_mfma_f32_16x16x32_bf16 v[252:255], v[60:63], v[92:95], v[252:255]
    s_waitcnt lgkmcnt(0)
    s_waitcnt vmcnt(7)
    v_mfma_f32_16x16x32_bf16 v[192:195], v[176:179], v[112:115], v[192:195]
    s_and_b32 s78, s14, 3
    s_getpc_b64 s[20:21]
    s_cmp_gt_u32 s78, s17
    s_cbranch_scc1 K_WS
    v_mfma_f32_16x16x32_bf16 v[208:211], v[180:183], v[112:115], v[208:211]
    s_sub_u32 s14, s14, s78
    v_add_u32 v6, s14, v4
    v_add_u32 v7, s14, v5
    v_mfma_f32_16x16x32_bf16 v[224:227], v[184:187], v[112:115], v[224:227]
    ds_read_b64_tr_b16 v[128:129], v6 offset:0
    ds_read_b64_tr_b16 v[130:131], v6 offset:512
    v_mfma_f32_16x16x32_bf16 v[240:243], v[188:191], v[112:115], v[240:243]
    ds_read_b64_tr_b16 v[132:133], v6 offset:8
    ds_read_b64_tr_b16 v[134:135], v6 offset:520
    s_waitcnt vmcnt(6)
    v_mfma_f32_16x16x32_bf16 v[196:199], v[176:179], v[116:119], v[196:199]
    ds_read_b64_tr_b16 v[136:137], v7 offset:0
    ds_read_b64_tr_b16 v[138:139], v7 offset:512
    v_mfma_f32_16x16x32_bf16 v[212:215], v[180:183], v[116:119], v[212:215]
    ds_read_b64_tr_b16 v[140:141], v7 offset:8
    ds_read_b64_tr_b16 v[142:143], v7 offset:520
    v_mfma_f32_16x16x32_bf16 v[228:231], v[184:187], v[116:119], v[228:231]
    v_mfma_f32_16x16x32_bf16 v[244:247], v[188:191], v[116:119], v[244:247]
    s_waitcnt vmcnt(5)
    v_mfma_f32_16x16x32_bf16 v[200:203], v[176:179], v[120:123], v[200:203]
    v_mfma_f32_16x16x32_bf16 v[216:219], v[180:183], v[120:123], v[216:219]
    v_mfma_f32_16x16x32_bf16 v[232:235], v[184:187], v[120:123], v[232:235]
    v_mfma_f32_16x16x32_bf16 v[248:251], v[188:191], v[120:123], v[248:251]
    s_waitcnt vmcnt(4)
    v_mfma_f32_16x16x32_bf16 v[204:207], v[176:179], v[124:127], v[204:207]
    v_mfma_f32_16x16x32_bf16 v[220:223], v[180:183], v[124:127], v[220:223]
    v_mfma_f32_16x16x32_bf16 v[236:239], v[184:187], v[124:127], v[236:239]
    v_mfma_f32_16x16x32_bf16 v[252:255], v[188:191], v[124:127], v[252:255]
    s_waitcnt lgkmcnt(0)
    s_waitcnt vmcnt(3)
    v_mfma_f32_16x16x32_bf16 v[196:199], v[128:131], v[100:103], v[196:199]
    v_mfma_f32_16x16x32_bf16 v[212:215], v[132:135], v[100:103], v[212:215]
    v_mfma_f32_16x16x32_bf16 v[228:231], v[136:139], v[100:103], v[228:231]
    v_mfma_f32_16x16x32_bf16 v[244:247], v[140:143], v[100:103], v[244:247]
    s_waitcnt vmcnt(2)
    v_mfma_f32_16x16x32_bf16 v[200:203], v[128:131], v[104:107], v[200:203]
    s_nop 2
    ds_write_b128 v19, v[196:199] offset:0
    v_mfma_f32_16x16x32_bf16 v[216:219], v[132:135], v[104:107], v[216:219]
    ds_write_b128 v19, v[212:215] offset:1024
    v_mfma_f32_16x16x32_bf16 v[232:235], v[136:139], v[104:107], v[232:235]
    ds_write_b128 v19, v[228:231] offset:2048
    v_mfma_f32_16x16x32_bf16 v[248:251], v[140:143], v[104:107], v[248:251]
    ds_write_b128 v19, v[244:247] offset:3072
    s_waitcnt vmcnt(1)
    v_mfma_f32_16x16x32_bf16 v[204:207], v[128:131], v[108:111], v[204:207]
    ds_write_b128 v19, v[200:203] offset:16384
    v_mfma_f32_16x16x32_bf16 v[220:223], v[132:135], v[108:111], v[220:223]
    ds_write_b128 v19, v[216:219] offset:17408
    v_mfma_f32_16x16x32_bf16 v[236:239], v[136:139], v[108:111], v[236:239]
    ds_write_b128 v19, v[232:235] offset:18432
    v_mfma_f32_16x16x32_bf16 v[252:255], v[140:143], v[108:111], v[252:255]
    ds_write_b128 v19, v[248:251] offset:19456
    s_waitcnt vmcnt(0)
    v_mfma_f32_16x16x32_bf16 v[192:195], v[128:131], v[96:99], v[192:195]
    ds_write_b128 v19, v[204:207] offset:32768
    v_mfma_f32_16x16x32_bf16 v[208:211], v[132:135], v[96:99], v[208:211]
    ds_write_b128 v19, v[220:223] offset:33792
    v_mfma_f32_16x16x32_bf16 v[224:227], v[136:139], v[96:99], v[224:227]
    ds_write_b128 v19, v[236:239] offset:34816
    v_mfma_f32_16x16x32_bf16 v[240:243], v[140:143], v[96:99], v[240:243]
    ds_write_b128 v19, v[252:255] offset:35840
    v_mov_b32 v13, 17
    ds_write_b8 v12, v13 offset:0
    ds_read_u8 v15, v11 offset:44
    s_waitcnt lgkmcnt(0)
    v_cmp_gt_u32 vcc, 1, v15
    s_cbranch_vccnz EP_15
    ds_read_b64_tr_b16 v[144:145], v16 offset:0
    ds_read_b64_tr_b16 v[146:147], v16 offset:512
    ds_read_b64_tr_b16 v[148:149], v16 offset:1024
    ds_read_b64_tr_b16 v[150:151], v16 offset:1536
    s_waitcnt lgkmcnt(3)
    v_lshlrev_b32 v152, 16, v144
    v_and_b32 v153, 0xffff0000, v144
    v_add_f32 v160, v160, v152
    v_add_f32 v161, v161, v153
    v_cvt_pk_bf16_f32 v160, v160, v161
    v_and_b32 v161, 0xffff0000, v160
    v_lshlrev_b32 v160, 16, v160
    v_lshlrev_b32 v154, 16, v145
    v_and_b32 v155, 0xffff0000, v145
    v_add_f32 v162, v162, v154
    v_add_f32 v163, v163, v155
    v_cvt_pk_bf16_f32 v162, v162, v163
    v_and_b32 v163, 0xffff0000, v162
    v_lshlrev_b32 v162, 16, v162
    s_waitcnt lgkmcnt(2)
    v_lshlrev_b32 v152, 16, v146
    v_and_b32 v153, 0xffff0000, v146
    v_add_f32 v164, v164, v152
    v_add_f32 v165, v165, v153
    v_cvt_pk_bf16_f32 v164, v164, v165
    v_and_b32 v165, 0xffff0000, v164
    v_lshlrev_b32 v164, 16, v164
    v_lshlrev_b32 v154, 16, v147
    v_and_b32 v155, 0xffff0000, v147
    v_add_f32 v166, v166, v154
    v_add_f32 v167, v167, v155
    v_cvt_pk_bf16_f32 v166, v166, v167
    v_and_b32 v167, 0xffff0000, v166
    v_lshlrev_b32 v166, 16, v166
    s_waitcnt lgkmcnt(1)
    v_lshlrev_b32 v152, 16, v148
    v_and_b32 v153, 0xffff0000, v148
    v_add_f32 v168, v168, v152
    v_add_f32 v169, v169, v153
    v_cvt_pk_bf16_f32 v168, v168, v169
    v_and_b32 v169, 0xffff0000, v168
    v_lshlrev_b32 v168, 16, v168
    v_lshlrev_b32 v154, 16, v149
    v_and_b32 v155, 0xffff0000, v149
    v_add_f32 v170, v170, v154
    v_add_f32 v171, v171, v155
    v_cvt_pk_bf16_f32 v170, v170, v171
    v_and_b32 v171, 0xffff0000, v170
    v_lshlrev_b32 v170, 16, v170
    s_waitcnt lgkmcnt(0)
    v_lshlrev_b32 v152, 16, v150
    v_and_b32 v153, 0xffff0000, v150
    v_add_f32 v172, v172, v152
    v_add_f32 v173, v173, v153
    v_cvt_pk_bf16_f32 v172, v172, v173
    v_and_b32 v173, 0xffff0000, v172
    v_lshlrev_b32 v172, 16, v172
    v_lshlrev_b32 v154, 16, v151
    v_and_b32 v155, 0xffff0000, v151
    v_add_f32 v174, v174, v154
    v_add_f32 v175, v175, v155
    v_cvt_pk_bf16_f32 v174, v174, v175
    v_and_b32 v175, 0xffff0000, v174
    v_lshlrev_b32 v174, 16, v174
    s_mov_b32 s83, 32768
SP_17:
    ds_read_u8 v15, v11 offset:0
    s_waitcnt lgkmcnt(0)
    v_cmp_gt_u32 vcc, 17, v15
    s_cbranch_vccz SD_18
    s_sub_u32 s83, s83, 1
    s_cmp_lg_u32 s83, 0
    s_cbranch_scc1 SP_17
SD_18:
    ds_read_b128 v[64:67], v20 offset:0
    ds_read_b128 v[32:35], v21 offset:16384
    ds_read_b128 v[80:83], v22 offset:32768
    ds_read_b128 v[68:71], v20 offset:1024
    ds_read_b128 v[36:39], v21 offset:17408
    ds_read_b128 v[84:87], v22 offset:33792
    ds_read_b128 v[72:75], v20 offset:2048
    ds_read_b128 v[40:43], v21 offset:18432
    ds_read_b128 v[88:91], v22 offset:34816
    ds_read_b128 v[76:79], v20 offset:3072
    ds_read_b128 v[44:47], v21 offset:19456
    ds_read_b128 v[92:95], v22 offset:35840
    s_waitcnt lgkmcnt(9)
    v_add_f32 v64, v64, v192
    v_add_f32 v32, v32, v80
    v_add_f32 v65, v65, v193
    v_add_f32 v33, v33, v81
    v_add_f32 v66, v66, v194
    v_add_f32 v34, v34, v82
    v_add_f32 v67, v67, v195
    v_add_f32 v35, v35, v83
    v_add_f32 v64, v64, v32
    v_add_f32 v65, v65, v33
    v_add_f32 v66, v66, v34
    v_add_f32 v67, v67, v35
    v_cvt_pk_bf16_f32 v64, v64, v65
    v_and_b32 v65, 0xffff0000, v64
    v_lshlrev_b32 v64, 16, v64
    v_cvt_pk_bf16_f32 v66, v66, v67
    v_and_b32 v67, 0xffff0000, v66
    v_lshlrev_b32 v66, 16, v66
    s_waitcnt lgkmcnt(6)
    v_add_f32 v68, v68, v208
    v_add_f32 v36, v36, v84
    v_add_f32 v69, v69, v209
    v_add_f32 v37, v37, v85
    v_add_f32 v70, v70, v210
    v_add_f32 v38, v38, v86
    v_add_f32 v71, v71, v211
    v_add_f32 v39, v39, v87
    v_add_f32 v68, v68, v36
    v_add_f32 v69, v69, v37
    v_add_f32 v70, v70, v38
    v_add_f32 v71, v71, v39
    v_cvt_pk_bf16_f32 v68, v68, v69
    v_and_b32 v69, 0xffff0000, v68
    v_lshlrev_b32 v68, 16, v68
    v_cvt_pk_bf16_f32 v70, v70, v71
    v_and_b32 v71, 0xffff0000, v70
    v_lshlrev_b32 v70, 16, v70
    s_waitcnt lgkmcnt(3)
    v_add_f32 v72, v72, v224
    v_add_f32 v40, v40, v88
    v_add_f32 v73, v73, v225
    v_add_f32 v41, v41, v89
    v_add_f32 v74, v74, v226
    v_add_f32 v42, v42, v90
    v_add_f32 v75, v75, v227
    v_add_f32 v43, v43, v91
    v_add_f32 v72, v72, v40
    v_add_f32 v73, v73, v41
    v_add_f32 v74, v74, v42
    v_add_f32 v75, v75, v43
    v_cvt_pk_bf16_f32 v72, v72, v73
    v_and_b32 v73, 0xffff0000, v72
    v_lshlrev_b32 v72, 16, v72
    v_cvt_pk_bf16_f32 v74, v74, v75
    v_and_b32 v75, 0xffff0000, v74
    v_lshlrev_b32 v74, 16, v74
    s_waitcnt lgkmcnt(0)
    v_add_f32 v76, v76, v240
    v_add_f32 v44, v44, v92
    v_add_f32 v77, v77, v241
    v_add_f32 v45, v45, v93
    v_add_f32 v78, v78, v242
    v_add_f32 v46, v46, v94
    v_add_f32 v79, v79, v243
    v_add_f32 v47, v47, v95
    v_add_f32 v76, v76, v44
    v_add_f32 v77, v77, v45
    v_add_f32 v78, v78, v46
    v_add_f32 v79, v79, v47
    v_cvt_pk_bf16_f32 v76, v76, v77
    v_and_b32 v77, 0xffff0000, v76
    v_lshlrev_b32 v76, 16, v76
    v_cvt_pk_bf16_f32 v78, v78, v79
    v_and_b32 v79, 0xffff0000, v78
    v_lshlrev_b32 v78, 16, v78
    s_branch EP_16
EP_15:
    s_mov_b32 s83, 32768
SP_19:
    ds_read_u8 v15, v11 offset:0
    s_waitcnt lgkmcnt(0)
    v_cmp_gt_u32 vcc, 17, v15
    s_cbranch_vccz SD_20
    s_sub_u32 s83, s83, 1
    s_cmp_lg_u32 s83, 0
    s_cbranch_scc1 SP_19
SD_20:
    ds_read_b128 v[64:67], v20 offset:0
    ds_read_b128 v[32:35], v21 offset:16384
    ds_read_b128 v[80:83], v22 offset:32768
    ds_read_b128 v[68:71], v20 offset:1024
    ds_read_b128 v[36:39], v21 offset:17408
    ds_read_b128 v[84:87], v22 offset:33792
    ds_read_b128 v[72:75], v20 offset:2048
    ds_read_b128 v[40:43], v21 offset:18432
    ds_read_b128 v[88:91], v22 offset:34816
    ds_read_b128 v[76:79], v20 offset:3072
    ds_read_b128 v[44:47], v21 offset:19456
    ds_read_b128 v[92:95], v22 offset:35840
    s_waitcnt lgkmcnt(9)
    v_add_f32 v64, v64, v192
    v_add_f32 v32, v32, v80
    v_add_f32 v65, v65, v193
    v_add_f32 v33, v33, v81
    v_add_f32 v66, v66, v194
    v_add_f32 v34, v34, v82
    v_add_f32 v67, v67, v195
    v_add_f32 v35, v35, v83
    v_add_f32 v64, v64, v32
    v_add_f32 v65, v65, v33
    v_add_f32 v66, v66, v34
    v_add_f32 v67, v67, v35
    v_cvt_pk_bf16_f32 v64, v64, v65
    v_and_b32 v65, 0xffff0000, v64
    v_lshlrev_b32 v64, 16, v64
    v_cvt_pk_bf16_f32 v66, v66, v67
    v_and_b32 v67, 0xffff0000, v66
    v_lshlrev_b32 v66, 16, v66
    s_waitcnt lgkmcnt(6)
    v_add_f32 v68, v68, v208
    v_add_f32 v36, v36, v84
    v_add_f32 v69, v69, v209
    v_add_f32 v37, v37, v85
    v_add_f32 v70, v70, v210
    v_add_f32 v38, v38, v86
    v_add_f32 v71, v71, v211
    v_add_f32 v39, v39, v87
    v_add_f32 v68, v68, v36
    v_add_f32 v69, v69, v37
    v_add_f32 v70, v70, v38
    v_add_f32 v71, v71, v39
    v_cvt_pk_bf16_f32 v68, v68, v69
    v_and_b32 v69, 0xffff0000, v68
    v_lshlrev_b32 v68, 16, v68
    v_cvt_pk_bf16_f32 v70, v70, v71
    v_and_b32 v71, 0xffff0000, v70
    v_lshlrev_b32 v70, 16, v70
    s_waitcnt lgkmcnt(3)
    v_add_f32 v72, v72, v224
    v_add_f32 v40, v40, v88
    v_add_f32 v73, v73, v225
    v_add_f32 v41, v41, v89
    v_add_f32 v74, v74, v226
    v_add_f32 v42, v42, v90
    v_add_f32 v75, v75, v227
    v_add_f32 v43, v43, v91
    v_add_f32 v72, v72, v40
    v_add_f32 v73, v73, v41
    v_add_f32 v74, v74, v42
    v_add_f32 v75, v75, v43
    v_cvt_pk_bf16_f32 v72, v72, v73
    v_and_b32 v73, 0xffff0000, v72
    v_lshlrev_b32 v72, 16, v72
    v_cvt_pk_bf16_f32 v74, v74, v75
    v_and_b32 v75, 0xffff0000, v74
    v_lshlrev_b32 v74, 16, v74
    s_waitcnt lgkmcnt(0)
    v_add_f32 v76, v76, v240
    v_add_f32 v44, v44, v92
    v_add_f32 v77, v77, v241
    v_add_f32 v45, v45, v93
    v_add_f32 v78, v78, v242
    v_add_f32 v46, v46, v94
    v_add_f32 v79, v79, v243
    v_add_f32 v47, v47, v95
    v_add_f32 v76, v76, v44
    v_add_f32 v77, v77, v45
    v_add_f32 v78, v78, v46
    v_add_f32 v79, v79, v47
    v_cvt_pk_bf16_f32 v76, v76, v77
    v_and_b32 v77, 0xffff0000, v76
    v_lshlrev_b32 v76, 16, v76
    v_cvt_pk_bf16_f32 v78, v78, v79
    v_and_b32 v79, 0xffff0000, v78
    v_lshlrev_b32 v78, 16, v78
    s_mov_b32 s83, 32768
SP_21:
    ds_read_u8 v15, v11 offset:44
    s_waitcnt lgkmcnt(0)
    v_cmp_gt_u32 vcc, 1, v15
    s_cbranch_vccz SD_22
    s_sleep 1
    s_sub_u32 s83, s83, 1
    s_cmp_lg_u32 s83, 0
    s_cbranch_scc1 SP_21
SD_22:
    ds_read_b64_tr_b16 v[144:145], v16 offset:0
    ds_read_b64_tr_b16 v[146:147], v16 offset:512
    ds_read_b64_tr_b16 v[148:149], v16 offset:1024
    ds_read_b64_tr_b16 v[150:151], v16 offset:1536
    s_waitcnt lgkmcnt(3)
    v_lshlrev_b32 v152, 16, v144
    v_and_b32 v153, 0xffff0000, v144
    v_add_f32 v160, v160, v152
    v_add_f32 v161, v161, v153
    v_cvt_pk_bf16_f32 v160, v160, v161
    v_and_b32 v161, 0xffff0000, v160
    v_lshlrev_b32 v160, 16, v160
    v_lshlrev_b32 v154, 16, v145
    v_and_b32 v155, 0xffff0000, v145
    v_add_f32 v162, v162, v154
    v_add_f32 v163, v163, v155
    v_cvt_pk_bf16_f32 v162, v162, v163
    v_and_b32 v163, 0xffff0000, v162
    v_lshlrev_b32 v162, 16, v162
    s_waitcnt lgkmcnt(2)
    v_lshlrev_b32 v152, 16, v146
    v_and_b32 v153, 0xffff0000, v146
    v_add_f32 v164, v164, v152
    v_add_f32 v165, v165, v153
    v_cvt_pk_bf16_f32 v164, v164, v165
    v_and_b32 v165, 0xffff0000, v164
    v_lshlrev_b32 v164, 16, v164
    v_lshlrev_b32 v154, 16, v147
    v_and_b32 v155, 0xffff0000, v147
    v_add_f32 v166, v166, v154
    v_add_f32 v167, v167, v155
    v_cvt_pk_bf16_f32 v166, v166, v167
    v_and_b32 v167, 0xffff0000, v166
    v_lshlrev_b32 v166, 16, v166
    s_waitcnt lgkmcnt(1)
    v_lshlrev_b32 v152, 16, v148
    v_and_b32 v153, 0xffff0000, v148
    v_add_f32 v168, v168, v152
    v_add_f32 v169, v169, v153
    v_cvt_pk_bf16_f32 v168, v168, v169
    v_and_b32 v169, 0xffff0000, v168
    v_lshlrev_b32 v168, 16, v168
    v_lshlrev_b32 v154, 16, v149
    v_and_b32 v155, 0xffff0000, v149
    v_add_f32 v170, v170, v154
    v_add_f32 v171, v171, v155
    v_cvt_pk_bf16_f32 v170, v170, v171
    v_and_b32 v171, 0xffff0000, v170
    v_lshlrev_b32 v170, 16, v170
    s_waitcnt lgkmcnt(0)
    v_lshlrev_b32 v152, 16, v150
    v_and_b32 v153, 0xffff0000, v150
    v_add_f32 v172, v172, v152
    v_add_f32 v173, v173, v153
    v_cvt_pk_bf16_f32 v172, v172, v173
    v_and_b32 v173, 0xffff0000, v172
    v_lshlrev_b32 v172, 16, v172
    v_lshlrev_b32 v154, 16, v151
    v_and_b32 v155, 0xffff0000, v151
    v_add_f32 v174, v174, v154
    v_add_f32 v175, v175, v155
    v_cvt_pk_bf16_f32 v174, v174, v175
    v_and_b32 v175, 0xffff0000, v174
    v_lshlrev_b32 v174, 16, v174
EP_16:
    v_add_f32 v64, v64, v160
    v_add_f32 v65, v65, v161
    v_cvt_pk_bf16_f32 v32, v64, v65
    v_add_f32 v66, v66, v162
    v_add_f32 v67, v67, v163
    v_cvt_pk_bf16_f32 v33, v66, v67
    v_add_f32 v68, v68, v164
    v_add_f32 v69, v69, v165
    v_cvt_pk_bf16_f32 v34, v68, v69
    v_add_f32 v70, v70, v166
    v_add_f32 v71, v71, v167
    v_cvt_pk_bf16_f32 v35, v70, v71
    buffer_store_dwordx4 v[32:35], v18, s[60:63], 0 offen offset:0
    v_add_f32 v72, v72, v168
    v_add_f32 v73, v73, v169
    v_cvt_pk_bf16_f32 v36, v72, v73
    v_add_f32 v74, v74, v170
    v_add_f32 v75, v75, v171
    v_cvt_pk_bf16_f32 v37, v74, v75
    v_add_f32 v76, v76, v172
    v_add_f32 v77, v77, v173
    v_cvt_pk_bf16_f32 v38, v76, v77
    v_add_f32 v78, v78, v174
    v_add_f32 v79, v79, v175
    v_cvt_pk_bf16_f32 v39, v78, v79
    buffer_store_dwordx4 v[36:39], v18, s[60:63], 0 offen offset:16
    s_endpgm
CLO_2:
    s_cmp_eq_u32 s85, 0
    s_cbranch_scc1 CL_1
    s_cmp_lg_u32 s75, 0
    s_cbranch_scc1 CL_1
    buffer_load_dwordx4 v[24:27], v18, s[52:55], 0 offen offset:0
    buffer_load_dwordx4 v[28:31], v18, s[52:55], 0 offen offset:512
    s_movk_i32 s76, 14336
    buffer_load_dword v32, v19, s[52:55], 0 offen offset:0
    buffer_load_dword v34, v19, s[52:55], s76 offen offset:0
    buffer_load_dword v36, v19, s[52:55], 0 offen offset:256
    buffer_load_dword v38, v19, s[52:55], s76 offen offset:256
    s_mov_b32 s75, 1
    s_branch CL_1
CLO_4:
    s_cmp_eq_u32 s85, 0
    s_cbranch_scc1 CL_3
    s_cmp_lg_u32 s75, 0
    s_cbranch_scc1 CL_3
    buffer_load_dwordx4 v[24:27], v18, s[52:55], 0 offen offset:0
    buffer_load_dwordx4 v[28:31], v18, s[52:55], 0 offen offset:512
    s_movk_i32 s76, 14336
    buffer_load_dword v32, v19, s[52:55], 0 offen offset:0
    buffer_load_dword v34, v19, s[52:55], s76 offen offset:0
    buffer_load_dword v36, v19, s[52:55], 0 offen offset:256
    buffer_load_dword v38, v19, s[52:55], s76 offen offset:256
    s_mov_b32 s75, 1
    s_branch CL_3
CLO_6:
    s_mov_b32 s83, 32768
CLP_7:
    ds_read_b64 v[22:23], v10 offset:8
    buffer_load_dword v17, v15, s[52:55], 0 offen sc1
    s_waitcnt vmcnt(0) lgkmcnt(0)
    v_readfirstlane_b32 s84, v22
    v_readfirstlane_b32 s85, v23
    s_nop 0
    v_cmp_ne_u32 vcc, s84, v17
    s_cmp_eq_u32 s85, 0
    s_cselect_b64 s[76:77], -1, vcc
    s_cmp_eq_u64 s[76:77], 0
    s_cbranch_scc1 CLP_8
    s_sleep 2
    s_sub_u32 s83, s83, 1
    s_cmp_lg_u32 s83, 0
    s_cbranch_scc1 CLP_7
CLP_8:
    buffer_load_dwordx4 v[24:27], v18, s[52:55], 0 offen offset:0
    buffer_load_dwordx4 v[28:31], v18, s[52:55], 0 offen offset:512
    s_movk_i32 s76, 14336
    buffer_load_dword v32, v19, s[52:55], 0 offen offset:0
    buffer_load_dword v34, v19, s[52:55], s76 offen offset:0
    buffer_load_dword v36, v19, s[52:55], 0 offen offset:256
    buffer_load_dword v38, v19, s[52:55], s76 offen offset:256
    s_mov_b32 s75, 1
    s_waitcnt vmcnt(0)
    s_branch CL_5
HS_10:
    s_mov_b32 s79, 32768
HS_11:
    s_mov_b64 exec, 0x3fff
    buffer_load_dword v14, v8, s[52:55], 0 offen sc1
    s_mov_b64 exec, -1
    s_waitcnt vmcnt(0)
    v_cmp_ne_u32 vcc, s84, v14
    s_nop 0
    s_and_b32 s76, vcc_lo, 0x1555
    s_cbranch_scc0 HJ_9
    s_sleep 3
    s_sub_u32 s79, s79, 1
    s_cmp_lg_u32 s79, 0
    s_cbranch_scc1 HS_11
    s_branch HJ_9
K_DS:
    s_mov_b64 exec, 0x3fff
    buffer_load_dword v14, v8, s[52:55], 0 offen sc1
    s_mov_b64 exec, -1
    s_sub_i32 s18, s18, 1
    s_max_i32 s18, s18, 0
    s_cmp_eq_u32 s18, 0
    s_cselect_b32 s19, -1, 0
    s_waitcnt vmcnt(0)
    v_cmp_eq_u32 vcc, s84, v14
    s_nop 0
    s_or_b32 s19, s19, vcc_lo
    s_and_b32 s19, s19, 0x2aaa
    s_or_b32 s37, s37, s19
    s_setpc_b64 s[20:21]
K_WS:
    ds_read_u8 v14, v15 offset:72
    s_sub_i32 s18, s18, 1
    s_max_i32 s18, s18, 0
    s_cmp_eq_u32 s18, 0
    s_cselect_b32 s19, 3, 0
    s_waitcnt lgkmcnt(0)
    v_readfirstlane_b32 s17, v14
    s_sleep 1
    s_or_b32 s17, s17, s19
    s_setpc_b64 s[20:21]
K_HELP:
    s_setprio 3
    s_load_dwordx2 s[60:61], s[0:1], 64
    s_memrealtime s[48:49]
    s_sub_u32 s5, s68, 4
    s_cmp_lg_u32 s68, 7
    s_cbranch_scc1 K_NZ
    v_lshlrev_b32 v2, 2, v1
    v_add_u32 v2, 158208, v2
    v_mov_b32 v3, 0
    ds_write_b32 v2, v3
    ds_write_b32 v2, v3 offset:512
K_NZ:
    s_and_b32 s4, s5, 1
    s_lshr_b32 s76, s5, 1
    s_sub_u32 s3, s2, 32
    s_lshl_b32 s3, s3, 1
    s_add_u32 s3, s3, s76
    s_mul_i32 s39, s76, 21248
    s_add_u32 s39, s39, 115712
    s_lshl_b32 s76, s3, 8
    s_lshl_b32 s77, s4, 7
    s_add_u32 s76, s76, s77
    v_add_u32 v2, s76, v1
    v_lshlrev_b32 v2, 1, v2
    s_lshl_b32 s77, s3, 1
    v_mov_b32 v3, s77
    s_waitcnt lgkmcnt(0)
    global_load_ushort v26, v3, s[30:31]
    global_load_ushort v20, v2, s[18:19] offset:0
    global_load_ushort v21, v2, s[20:21] offset:0
    global_load_ushort v22, v2, s[22:23] offset:0
    global_load_ushort v23, v2, s[24:25] offset:0
    global_load_ushort v24, v2, s[26:27] offset:0
    global_load_ushort v25, v2, s[28:29] offset:0
    global_load_ushort v120, v2, s[18:19] offset:128
    global_load_ushort v121, v2, s[20:21] offset:128
    global_load_ushort v122, v2, s[22:23] offset:128
    global_load_ushort v123, v2, s[24:25] offset:128
    global_load_ushort v124, v2, s[26:27] offset:128
    global_load_ushort v125, v2, s[28:29] offset:128
    global_load_ushort v160, v3, s[60:61]
    s_setprio 2
    s_barrier
    s_add_u32 s52, s14, 0x7000000
    s_addc_u32 s53, s15, 0
    s_and_b32 s53, s53, 0xffff
    s_and_b32 s52, s52, 0xfe000000
    s_mov_b32 s54, 0x2000000
    s_mov_b32 s55, 0x00020000
    s_mul_i32 s36, s5, 4352
    s_add_u32 s36, s36, 98304
    v_and_b32 v7, 15, v1
    v_lshrrev_b32 v6, 4, v1
    v_mul_u32_u24 v5, 272, v7
    v_lshl_add_u32 v8, v6, 4, s36
    v_add_u32 v5, v5, v8
    v_lshlrev_b32 v9, 2, v7
    v_and_b32 v9, 31, v9
    v_cmp_gt_u32 vcc, 8, v7
    v_mov_b32 v10, 0xcbaaa988
    v_mov_b32 v11, 0x76543210
    v_cndmask_b32 v10, v10, v11, vcc
    v_lshrrev_b32 v10, v9, v10
    v_and_b32 v10, 15, v10
    v_mul_u32_u24 v10, 272, v10
    v_add_u32 v12, v10, v8
    v_mov_b32 v10, 0x55444333
    v_mov_b32 v11, 0x22111000
    v_cndmask_b32 v10, v10, v11, vcc
    v_lshrrev_b32 v10, v9, v10
    v_and_b32 v10, 15, v10
    v_mul_u32_u24 v10, 272, v10
    v_add_u32 v13, v10, v8
    v_mov_b32 v10, 0x99988888
    v_mov_b32 v11, 0x77766666
    v_cndmask_b32 v10, v10, v11, vcc
    v_lshrrev_b32 v10, v9, v10
    v_and_b32 v10, 15, v10
    v_mul_u32_u24 v10, 272, v10
    v_add_u32 v14, v10, v8
    v_mov_b32 v10, 0xdddccccc
    v_mov_b32 v11, 0xbbbaaaaa
    v_cndmask_b32 v10, v10, v11, vcc
    v_lshrrev_b32 v10, v9, v10
    v_and_b32 v10, 15, v10
    v_mul_u32_u24 v10, 272, v10
    v_add_u32 v15, v10, v8
    s_add_u32 s76, s5, 158208
    v_mov_b32 v161, s76
    s_xor_b32 s77, s5, 1
    s_add_u32 s77, s77, 158208
    v_mov_b32 v162, s77
    v_mov_b32 v163, 1
    s_mov_b32 s64, s12
    s_and_b32 s65, s13, 0xffff
    s_mov_b32 s66, 0x100
    s_mov_b32 s67, 0x00020000
    s_and_b32 s76, s2, 7
    s_lshl_b32 s76, s76, 13
    s_add_u32 s76, s76, 7733248
    v_and_b32 v112, 31, v1
    v_lshl_add_u32 v112, v112, 8, s76
    v_mov_b32 v113, 64
    v_mov_b32 v114, 158216
    s_cmp_lg_u32 s5, 0
    s_cselect_b32 s86, 0, 1
    s_mov_b32 s56, s8
    s_and_b32 s57, s9, 0xffff
    s_mov_b32 s58, 0x188000
    s_mov_b32 s59, 0x00020000
    v_lshrrev_b32 v16, 3, v1
    s_mul_i32 s76, s5, 401408
    v_mul_u32_u24 v16, 896, v16
    s_lshl_b32 s77, s74, 7
    s_add_u32 s76, s76, s77
    v_add_u32 v16, s76, v16
    v_bfe_u32 v18, v1, 4, 1
    v_xor_b32 v17, v1, v18
    v_and_b32 v17, 7, v17
    v_lshl_add_u32 v170, v17, 4, v16
    v_lshlrev_b32 v172, 4, v1
    s_cmp_lg_u32 s15, 0
    s_cselect_b32 s76, 31, 30
    s_lshl_b32 s76, s76, 2
    v_mov_b32 v173, s76
    v_lshl_add_u32 v18, v1, 4, s36
    s_xor_b32 s76, s5, 1
    s_mul_i32 s76, s76, 4352
    s_add_u32 s76, s76, 98304
    v_lshl_add_u32 v19, v1, 4, s76
    v_and_b32 v10, v6, v7
    v_and_b32 v10, s4, v10
    v_cmp_ne_u32 s[16:17], 0, v10
    v_lshrrev_b32 v10, 1, v6
    v_lshlrev_b32 v10, 9, v10
    v_lshl_add_u32 v10, v7, 4, v10
    v_and_b32 v11, 1, v6
    v_lshl_add_u32 v10, v11, 3, v10
    s_add_u32 s76, s39, 2808
    s_lshl_b32 s78, s4, 11
    s_sub_u32 s76, s76, s78
    v_sub_u32 v115, s76, v10
    v_and_b32 v118, 3, v1
    v_add_u32 v118, 158208, v118
    v_lshlrev_b32 v4, 4, v1
    v_mov_b32 v60, 0
    v_mov_b32 v61, 0
    v_mov_b32 v62, 0
    v_mov_b32 v63, 0
    v_add_u32 v119, 16640, v4
    v_bfe_u32 v10, v1, 2, 2
    v_mul_u32_u24 v10, 4160, v10
    v_and_b32 v11, 3, v1
    v_lshl_add_u32 v10, v11, 4, v10
    v_add_u32 v10, 4096, v10
    v_cmp_gt_u32 vcc, 32, v1
    s_nop 1
    v_cndmask_b32 v119, v10, v119, vcc
    v_add_u32 v119, s39, v119
    v_sub_u32 v10, 3, v7
    v_and_b32 v10, 3, v10
    v_mul_u32_u24 v171, 4160, v10
    v_add_u32 v11, v7, v10
    v_sub_u32 v11, 15, v11
    v_lshl_add_u32 v11, v6, 3, v11
    v_lshl_add_u32 v171, v11, 1, v171
    s_lshl_b32 s76, s4, 8
    s_sub_u32 s77, s39, s76
    v_add_u32 v171, s77, v171
    v_lshlrev_b32 v175, 5, v7
    v_lshl_add_u32 v175, v6, 4, v175
    v_add_u32 v175, 16640, v175
    v_add_u32 v175, s77, v175
    s_add_u32 s79, s39, s78
    v_add_u32 v168, s79, v4
    s_and_b32 s76, s5, 2
    s_lshl_b32 s76, s76, 2
    s_add_u32 s76, s76, 158256
    v_mov_b32 v9, s76
    s_waitcnt vmcnt(0)
    v_mov_b32 v2, v7
    v_mov_b32 v3, v6
    s_mov_b32 exec_lo, s86
    s_mov_b32 exec_hi, 0
    buffer_load_dwordx2 v[116:117], v113, s[64:67], 0 offen sc1
    s_mov_b64 exec, -1
    v_lshlrev_b32 v20, 16, v20
    v_lshlrev_b32 v21, 16, v21
    v_lshlrev_b32 v22, 16, v22
    v_lshlrev_b32 v23, 16, v23
    v_lshlrev_b32 v24, 16, v24
    v_lshlrev_b32 v25, 16, v25
    v_lshlrev_b32 v120, 16, v120
    v_lshlrev_b32 v121, 16, v121
    v_lshlrev_b32 v122, 16, v122
    v_lshlrev_b32 v123, 16, v123
    v_lshlrev_b32 v124, 16, v124
    v_lshlrev_b32 v125, 16, v125
    v_lshlrev_b32 v26, 16, v26
    v_mul_f32 v26, 0x3fb8aa3b, v26
    v_exp_f32 v26, v26
    s_nop 0
    v_cvt_pk_bf16_f32 v26, v26, v26
    v_lshlrev_b32 v26, 16, v26
    v_mul_f32 v20, v26, v20
    v_mul_f32 v21, v26, v21
    v_mul_f32 v22, v26, v22
    v_mul_f32 v23, v26, v23
    v_mul_f32 v28, v24, v22
    v_fma_f32 v28, -v25, v23, v28
    v_mul_f32 v29, v24, v23
    v_fma_f32 v29, v25, v22, v29
    v_mul_f32 v120, v26, v120
    v_mul_f32 v121, v26, v121
    v_mul_f32 v122, v26, v122
    v_mul_f32 v123, v26, v123
    v_mul_f32 v126, v124, v122
    v_fma_f32 v126, -v125, v123, v126
    v_mul_f32 v127, v124, v123
    v_fma_f32 v127, v125, v122, v127
    v_max_f32 v27, abs(v28), abs(v29)
    v_max3_f32 v27, abs(v126), abs(v127), v27
    s_nop 1
    v_max_f32_dpp v27, v27, v27 row_shr:1 row_mask:0xf bank_mask:0xf
    s_nop 1
    v_max_f32_dpp v27, v27, v27 row_shr:2 row_mask:0xf bank_mask:0xf
    s_nop 1
    v_max_f32_dpp v27, v27, v27 row_shr:4 row_mask:0xf bank_mask:0xf
    s_nop 1
    v_max_f32_dpp v27, v27, v27 row_shr:8 row_mask:0xf bank_mask:0xf
    s_nop 1
    v_max_f32_dpp v27, v27, v27 row_bcast:15 row_mask:0xa bank_mask:0xf
    s_nop 1
    v_max_f32_dpp v27, v27, v27 row_bcast:31 row_mask:0xc bank_mask:0xf
    s_nop 0
    v_readlane_b32 s7, v27, 63
    s_nop 0
    s_lshr_b32 s7, s7, 23
    s_add_u32 s7, s7, 1
    v_mov_b32 v10, s7
    s_lshl_b32 s77, s5, 2
    s_add_u32 s77, s77, 158256
    v_mov_b32 v11, s77
    ds_write_b32 v11, v10
    s_mov_b32 m0, s36
    v_mul_f32 v16, 0x4138aa3b, v20
    v_mul_f32 v17, 0x3fa2f983, v21
    v_exp_f32 v16, v16
    v_fract_f32 v17, v17
    v_cos_f32 v32, v17
    v_sin_f32 v33, v17
    v_mul_f32 v32, v16, v32
    v_mul_f32 v33, v16, v33
    v_mul_f32 v16, 0x3fb8aa3b, v20
    v_mul_f32 v17, 0x3e22f983, v21
    v_exp_f32 v16, v16
    v_fract_f32 v17, v17
    v_cos_f32 v30, v17
    v_sin_f32 v31, v17
    v_mul_f32 v30, v16, v30
    v_mul_f32 v31, v16, v31
    v_mul_f32 v16, 0x43b8aa3b, v20
    v_mul_f32 v17, 0x4222f983, v21
    v_exp_f32 v16, v16
    v_fract_f32 v17, v17
    v_cos_f32 v34, v17
    v_sin_f32 v35, v17
    v_mul_f32 v34, v16, v34
    v_mul_f32 v35, v16, v35
    v_mul_f32 v42, v32, v33
    v_mul_f32 v40, v32, v32
    v_fma_f32 v40, -v33, v33, v40
    v_fma_f32 v41, v33, v32, v42
    v_mul_f32 v43, v30, v31
    v_mul_f32 v36, v30, v30
    v_fma_f32 v36, -v31, v31, v36
    v_fma_f32 v37, v31, v30, v43
    v_mul_f32 v44, v36, v37
    v_mul_f32 v38, v36, v36
    v_fma_f32 v38, -v37, v37, v38
    v_fma_f32 v39, v37, v36, v44
    v_mov_b32 v50, 1.0
    v_mov_b32 v51, 0
    v_cvt_pk_f16_f32 v46, v50, v51
    ds_write_addtid_b32 v46 offset:0
    v_cvt_pk_f16_f32 v47, v32, v33
    ds_write_addtid_b32 v47 offset:272
    v_mul_f32 v45, v32, v41
    v_mul_f32 v52, v32, v40
    v_fma_f32 v52, -v33, v41, v52
    v_fma_f32 v53, v33, v40, v45
    v_cvt_pk_f16_f32 v48, v40, v41
    ds_write_addtid_b32 v48 offset:544
    v_cvt_pk_f16_f32 v49, v52, v53
    ds_write_addtid_b32 v49 offset:816
    v_mul_f32 v42, v40, v41
    v_mul_f32 v50, v40, v40
    v_fma_f32 v50, -v41, v41, v50
    v_fma_f32 v51, v41, v40, v42
    v_mul_f32 v43, v52, v41
    v_mul_f32 v52, v52, v40
    v_fma_f32 v52, -v53, v41, v52
    v_fma_f32 v53, v53, v40, v43
    v_cvt_pk_f16_f32 v46, v50, v51
    ds_write_addtid_b32 v46 offset:1088
    v_cvt_pk_f16_f32 v47, v52, v53
    ds_write_addtid_b32 v47 offset:1360
    v_mul_f32 v44, v50, v41
    v_mul_f32 v50, v50, v40
    v_fma_f32 v50, -v51, v41, v50
    v_fma_f32 v51, v51, v40, v44
    v_mul_f32 v45, v52, v41
    v_mul_f32 v52, v52, v40
    v_fma_f32 v52, -v53, v41, v52
    v_fma_f32 v53, v53, v40, v45
    v_cvt_pk_f16_f32 v48, v50, v51
    ds_write_addtid_b32 v48 offset:1632
    v_cvt_pk_f16_f32 v49, v52, v53
    ds_write_addtid_b32 v49 offset:1904
    v_mul_f32 v42, v50, v41
    v_mul_f32 v50, v50, v40
    v_fma_f32 v50, -v51, v41, v50
    v_fma_f32 v51, v51, v40, v42
    v_mul_f32 v43, v52, v41
    v_mul_f32 v52, v52, v40
    v_fma_f32 v52, -v53, v41, v52
    v_fma_f32 v53, v53, v40, v43
    v_cvt_pk_f16_f32 v46, v50, v51
    ds_write_addtid_b32 v46 offset:2176
    v_cvt_pk_f16_f32 v47, v52, v53
    ds_write_addtid_b32 v47 offset:2448
    v_mul_f32 v44, v50, v41
    v_mul_f32 v50, v50, v40
    v_fma_f32 v50, -v51, v41, v50
    v_fma_f32 v51, v51, v40, v44
    v_mul_f32 v45, v52, v41
    v_mul_f32 v52, v52, v40
    v_fma_f32 v52, -v53, v41, v52
    v_fma_f32 v53, v53, v40, v45
    v_cvt_pk_f16_f32 v48, v50, v51
    ds_write_addtid_b32 v48 offset:2720
    v_cvt_pk_f16_f32 v49, v52, v53
    ds_write_addtid_b32 v49 offset:2992
    v_mul_f32 v42, v50, v41
    v_mul_f32 v50, v50, v40
    v_fma_f32 v50, -v51, v41, v50
    s_sub_u32 s76, s2, 32
    s_lshl_b32 s76, s76, 2
    s_add_u32 s76, s76, s5
    s_mul_i32 s77, s76, 1792
    v_lshl_add_u32 v252, v1, 7, s77
    s_mov_b64 exec, 0x3fff
    global_load_dword v252, v252, s[8:9]
    s_mov_b64 exec, -1
    v_fma_f32 v51, v51, v40, v42
    v_mul_f32 v43, v52, v41
    s_lshl_b32 s76, s70, 1
    s_lshr_b32 s77, s5, 1
    s_add_u32 s76, s76, s77
    s_mul_i32 s77, s76, 37
    s_lshr_b32 s77, s77, 8
    s_add_u32 s76, s76, s77
    s_lshl_b32 s77, s69, 1
    s_add_u32 s77, s77, s4
    s_lshl_b32 s77, s77, 5
    s_add_u32 s76, s76, s77
    s_lshl_b32 s76, s76, 8
    s_add_u32 s76, s76, 7340032
    v_mov_b32 v174, s76
    s_and_b32 s76, s3, 0xfffe
    s_add_u32 s76, s76, s4
    s_lshl_b32 s76, s76, 8
    s_add_u32 s76, s76, 7602176
    v_writelane_b32 v174, s76, 1
    s_mov_b64 exec, 3
    buffer_load_dword v174, v174, s[52:55], 0 offen sc1
    s_mov_b64 exec, -1
    v_mul_f32 v52, v52, v40
    v_fma_f32 v52, -v53, v41, v52
    v_fma_f32 v53, v53, v40, v43
    v_cvt_pk_f16_f32 v46, v50, v51
    ds_write_addtid_b32 v46 offset:3264
    v_cvt_pk_f16_f32 v47, v52, v53
    ds_write_addtid_b32 v47 offset:3536
    v_mul_f32 v44, v50, v41
    v_mul_f32 v50, v50, v40
    v_fma_f32 v50, -v51, v41, v50
    v_fma_f32 v51, v51, v40, v44
    ds_read_b64 v[10:11], v9
    v_mul_f32 v45, v52, v41
    v_mul_f32 v52, v52, v40
    v_fma_f32 v52, -v53, v41, v52
    v_fma_f32 v53, v53, v40, v45
    v_cvt_pk_f16_f32 v48, v50, v51
    ds_write_addtid_b32 v48 offset:3808
    v_cvt_pk_f16_f32 v49, v52, v53
    ds_write_addtid_b32 v49 offset:4080
    v_mul_f32 v42, v50, v41
    v_mul_f32 v50, v50, v40
    v_fma_f32 v50, -v51, v41, v50
    v_fma_f32 v51, v51, v40, v42
    ds_read_b128 v[64:67], v5 offset:0
    ds_read_b128 v[68:71], v5 offset:64
    ds_read_b128 v[72:75], v5 offset:128
    ds_read_b128 v[76:79], v5 offset:192
    v_mul_f32 v43, v52, v41
    v_mul_f32 v52, v52, v40
    v_fma_f32 v52, -v53, v41, v52
    v_fma_f32 v53, v53, v40, v43
    v_cvt_pk_f16_f32 v46, v50, v51
    ds_write_addtid_b32 v46 offset:0
    v_cvt_pk_f16_f32 v47, v52, v53
    ds_write_addtid_b32 v47 offset:272
    v_mul_f32 v44, v50, v41
    v_mul_f32 v50, v50, v40
    v_fma_f32 v50, -v51, v41, v50
    v_fma_f32 v51, v51, v40, v44
    v_mul_f32 v45, v52, v41
    v_mul_f32 v52, v52, v40
    v_fma_f32 v52, -v53, v41, v52
    v_fma_f32 v53, v53, v40, v45
    v_cvt_pk_f16_f32 v48, v50, v51
    ds_write_addtid_b32 v48 offset:544
    v_cvt_pk_f16_f32 v49, v52, v53
    ds_write_addtid_b32 v49 offset:816
    v_mul_f32 v42, v50, v41
    v_mul_f32 v50, v50, v40
    v_fma_f32 v50, -v51, v41, v50
    v_fma_f32 v51, v51, v40, v42
    v_mul_f32 v43, v52, v41
    v_mul_f32 v52, v52, v40
    v_fma_f32 v52, -v53, v41, v52
    v_fma_f32 v53, v53, v40, v43
    v_cvt_pk_f16_f32 v46, v50, v51
    ds_write_addtid_b32 v46 offset:1088
    v_cvt_pk_f16_f32 v47, v52, v53
    ds_write_addtid_b32 v47 offset:1360
    v_mul_f32 v44, v50, v41
    v_mul_f32 v50, v50, v40
    v_fma_f32 v50, -v51, v41, v50
    v_fma_f32 v51, v51, v40, v44
    v_mul_f32 v45, v52, v41
    v_mul_f32 v52, v52, v40
    v_fma_f32 v52, -v53, v41, v52
    v_fma_f32 v53, v53, v40, v45
    v_cvt_pk_f16_f32 v48, v50, v51
    ds_write_addtid_b32 v48 offset:1632
    v_cvt_pk_f16_f32 v49, v52, v53
    ds_write_addtid_b32 v49 offset:1904
    v_mul_f32 v42, v50, v41
    v_mul_f32 v50, v50, v40
    v_fma_f32 v50, -v51, v41, v50
    v_fma_f32 v51, v51, v40, v42
    v_mul_f32 v43, v52, v41
    v_mul_f32 v52, v52, v40
    v_fma_f32 v52, -v53, v41, v52
    v_fma_f32 v53, v53, v40, v43
    v_cvt_pk_f16_f32 v46, v50, v51
    ds_write_addtid_b32 v46 offset:2176
    v_cvt_pk_f16_f32 v47, v52, v53
    ds_write_addtid_b32 v47 offset:2448
    v_mul_f32 v44, v50, v41
    v_mul_f32 v50, v50, v40
    v_fma_f32 v50, -v51, v41, v50
    v_fma_f32 v51, v51, v40, v44
    v_mul_f32 v45, v52, v41
    v_mul_f32 v52, v52, v40
    v_fma_f32 v52, -v53, v41, v52
    v_fma_f32 v53, v53, v40, v45
    v_cvt_pk_f16_f32 v48, v50, v51
    ds_write_addtid_b32 v48 offset:2720
    v_cvt_pk_f16_f32 v49, v52, v53
    ds_write_addtid_b32 v49 offset:2992
    v_mul_f32 v42, v50, v41
    v_mul_f32 v50, v50, v40
    v_fma_f32 v50, -v51, v41, v50
    v_fma_f32 v51, v51, v40, v42
    v_mul_f32 v43, v52, v41
    v_mul_f32 v52, v52, v40
    v_fma_f32 v52, -v53, v41, v52
    v_fma_f32 v53, v53, v40, v43
    v_cvt_pk_f16_f32 v46, v50, v51
    ds_write_addtid_b32 v46 offset:3264
    v_cvt_pk_f16_f32 v47, v52, v53
    ds_write_addtid_b32 v47 offset:3536
    v_mul_f32 v44, v50, v41
    v_mul_f32 v50, v50, v40
    v_fma_f32 v50, -v51, v41, v50
    v_fma_f32 v51, v51, v40, v44
    v_mul_f32 v45, v52, v41
    v_mul_f32 v52, v52, v40
    v_fma_f32 v52, -v53, v41, v52
    v_fma_f32 v53, v53, v40, v45
    v_cvt_pk_f16_f32 v48, v50, v51
    ds_write_addtid_b32 v48 offset:3808
    v_cvt_pk_f16_f32 v49, v52, v53
    ds_write_addtid_b32 v49 offset:4080
    ds_read_b128 v[80:83], v5 offset:0
    ds_read_b128 v[84:87], v5 offset:64
    ds_read_b128 v[88:91], v5 offset:128
    ds_read_b128 v[92:95], v5 offset:192
    s_mov_b32 s83, 32768
    s_waitcnt lgkmcnt(15)
    s_branch KS_25
KS_23:
    ds_read_b64 v[10:11], v9
    s_waitcnt lgkmcnt(0)
KS_25:
    v_readfirstlane_b32 s76, v10
    v_readfirstlane_b32 s77, v11
    s_nop 0
    s_min_u32 s6, s76, s77
    s_cmp_lg_u32 s6, 0
    s_cbranch_scc1 KS_24
    s_sub_u32 s83, s83, 1
    s_cmp_lg_u32 s83, 0
    s_cbranch_scc1 KS_23
KS_24:
    s_max_u32 s7, s76, s77
    s_sub_u32 s6, 255, s7
    s_lshl_b32 s6, s6, 23
    s_sub_u32 s7, s7, 1
    s_lshl_b32 s7, s7, 23
    v_mul_f32 v28, s6, v28
    v_mul_f32 v29, s6, v29
    v_mul_f32 v126, s6, v126
    v_mul_f32 v127, s6, v127
    s_cmp_eq_u32 s86, 0
    s_cbranch_scc1 NF_26
    s_mov_b32 s83, 32768
    s_mov_b32 s49, 2
    s_branch GN_29
GN_27:
    buffer_load_dwordx2 v[116:117], v113, s[64:67], 0 offen sc1
GN_29:
    s_waitcnt vmcnt(0)
    v_readfirstlane_b32 s84, v116
    v_readfirstlane_b32 s85, v117
    s_nop 0
    s_cmp_eq_u32 s85, 0
    s_cbranch_scc1 GN_30
    s_sub_u32 s76, s48, s84
    s_cmp_lt_i32 s76, 800
    s_cbranch_scc1 GN_28
    s_sub_u32 s49, s49, 1
    s_cbranch_scc1 GN_28
GN_30:
    s_sleep 8
    s_sub_u32 s83, s83, 1
    s_cmp_lg_u32 s83, 0
    s_cbranch_scc1 GN_27
GN_28:
    s_mov_b64 exec, 1
    ds_write_b64 v114, v[116:117] offset:8
    s_mov_b64 exec, -1
NF_26:
    v_cvt_pk_f16_f32 v46, v28, -v29
    ds_write_addtid_b32 v46 offset:0
    v_mul_f32 v42, v28, v31
    v_mul_f32 v54, v28, v30
    v_fma_f32 v54, -v29, v31, v54
    v_fma_f32 v55, v29, v30, v42
    v_mul_f32 v43, v28, v35
    v_mul_f32 v56, v28, v34
    v_fma_f32 v56, -v29, v35, v56
    v_fma_f32 v57, v29, v34, v43
    v_cvt_pk_f16_f32 v47, v54, -v55
    ds_write_addtid_b32 v47 offset:272
    v_cvt_pk_f16_f32 v48, v56, -v57
    ds_write_addtid_b32 v48 offset:2176
    v_mul_f32 v44, v56, v37
    v_mul_f32 v58, v56, v36
    v_fma_f32 v58, -v57, v37, v58
    v_fma_f32 v59, v57, v36, v44
    v_mul_f32 v45, v54, v31
    s_mov_b32 s81, 143360
    buffer_load_dwordx4 v[176:179], v170, s[56:59], s81 offen
    v_mul_f32 v54, v54, v30
    v_fma_f32 v54, -v55, v31, v54
    v_fma_f32 v55, v55, v30, v45
    v_cvt_pk_f16_f32 v49, v54, -v55
    ds_write_addtid_b32 v49 offset:544
    v_cvt_pk_f16_f32 v46, v58, -v59
    ds_write_addtid_b32 v46 offset:2448
    v_mul_f32 v42, v58, v37
    v_mul_f32 v58, v58, v36
    v_fma_f32 v58, -v59, v37, v58
    v_fma_f32 v59, v59, v36, v42
    v_mul_f32 v43, v54, v31
    v_mul_f32 v54, v54, v30
    v_fma_f32 v54, -v55, v31, v54
    v_fma_f32 v55, v55, v30, v43
    v_cvt_pk_f16_f32 v47, v54, -v55
    ds_write_addtid_b32 v47 offset:816
    v_cvt_pk_f16_f32 v48, v58, -v59
    ds_write_addtid_b32 v48 offset:2720
    v_mul_f32 v44, v58, v37
    s_mov_b32 s81, 150528
    buffer_load_dwordx4 v[180:183], v170, s[56:59], s81 offen
    v_mul_f32 v58, v58, v36
    v_fma_f32 v58, -v59, v37, v58
    v_fma_f32 v59, v59, v36, v44
    v_mul_f32 v45, v54, v31
    v_mul_f32 v54, v54, v30
    v_fma_f32 v54, -v55, v31, v54
    v_fma_f32 v55, v55, v30, v45
    v_cvt_pk_f16_f32 v49, v54, -v55
    ds_write_addtid_b32 v49 offset:1088
    v_cvt_pk_f16_f32 v46, v58, -v59
    ds_write_addtid_b32 v46 offset:2992
    v_mul_f32 v42, v58, v37
    v_mul_f32 v58, v58, v36
    v_fma_f32 v58, -v59, v37, v58
    v_fma_f32 v59, v59, v36, v42
    v_mul_f32 v43, v54, v31
    v_mul_f32 v54, v54, v30
    v_fma_f32 v54, -v55, v31, v54
    v_fma_f32 v55, v55, v30, v43
    v_cvt_pk_f16_f32 v47, v54, -v55
    s_mov_b32 s81, 157696
    buffer_load_dwordx4 v[184:187], v170, s[56:59], s81 offen
    ds_write_addtid_b32 v47 offset:1360
    v_cvt_pk_f16_f32 v48, v58, -v59
    ds_write_addtid_b32 v48 offset:3264
    v_mul_f32 v44, v54, v31
    v_mul_f32 v54, v54, v30
    v_fma_f32 v54, -v55, v31, v54
    v_fma_f32 v55, v55, v30, v44
    v_cvt_pk_f16_f32 v49, v54, -v55
    ds_write_addtid_b32 v49 offset:1632
    v_mul_f32 v45, v54, v31
    v_mul_f32 v54, v54, v30
    v_fma_f32 v54, -v55, v31, v54
    v_fma_f32 v55, v55, v30, v45
    v_cvt_pk_f16_f32 v46, v54, -v55
    ds_write_addtid_b32 v46 offset:1904
    ds_read_b128 v[96:99], v12 offset:0
    ds_read_b128 v[100:103], v12 offset:64
    ds_read_b128 v[104:107], v12 offset:128
    ds_read_b128 v[108:111], v12 offset:192
    v_mul_f32 v42, v56, v35
    s_mov_b32 s81, 164864
    buffer_load_dwordx4 v[188:191], v170, s[56:59], s81 offen
    v_mul_f32 v56, v56, v34
    v_fma_f32 v56, -v57, v35, v56
    v_fma_f32 v57, v57, v34, v42
    v_cvt_pk_f16_f32 v47, v56, -v57
    ds_write_addtid_b32 v47 offset:0
    v_mul_f32 v43, v56, v39
    v_mul_f32 v58, v56, v38
    v_fma_f32 v58, -v57, v39, v58
    v_fma_f32 v59, v57, v38, v43
    v_cvt_pk_f16_f32 v48, v58, -v59
    ds_write_addtid_b32 v48 offset:272
    v_mul_f32 v44, v56, v33
    v_mul_f32 v54, v56, v32
    v_fma_f32 v54, -v57, v33, v54
    v_fma_f32 v55, v57, v32, v44
    v_cvt_pk_f16_f32 v49, v54, -v55
    ds_write_addtid_b32 v49 offset:544
    v_mul_f32 v45, v56, v35
    v_mul_f32 v56, v56, v34
    v_fma_f32 v56, -v57, v35, v56
    s_mov_b32 s81, 200704
    buffer_load_dwordx4 v[192:195], v170, s[56:59], s81 offen
    v_fma_f32 v57, v57, v34, v45
    v_cvt_pk_f16_f32 v46, v56, -v57
    ds_write_addtid_b32 v46 offset:816
    v_mul_f32 v42, v56, v39
    v_mul_f32 v58, v56, v38
    v_fma_f32 v58, -v57, v39, v58
    v_fma_f32 v59, v57, v38, v42
    v_cvt_pk_f16_f32 v47, v58, -v59
    ds_write_addtid_b32 v47 offset:1088
    v_mul_f32 v43, v56, v33
    v_mul_f32 v54, v56, v32
    v_fma_f32 v54, -v57, v33, v54
    v_fma_f32 v55, v57, v32, v43
    v_cvt_pk_f16_f32 v48, v54, -v55
    ds_write_addtid_b32 v48 offset:1360
    s_waitcnt lgkmcnt(6)
    v_mfma_f32_16x16x32_f16 v[128:131], v[96:99], v[64:67], 0
    v_mfma_f32_16x16x32_f16 v[132:135], v[96:99], v[80:83], 0
    v_mfma_f32_16x16x32_f16 v[128:131], v[100:103], v[68:71], v[128:131]
    v_mfma_f32_16x16x32_f16 v[132:135], v[100:103], v[84:87], v[132:135]
    s_mov_b32 s81, 207872
    buffer_load_dwordx4 v[196:199], v170, s[56:59], s81 offen
    v_mfma_f32_16x16x32_f16 v[128:131], v[104:107], v[72:75], v[128:131]
    v_mfma_f32_16x16x32_f16 v[132:135], v[104:107], v[88:91], v[132:135]
    v_mfma_f32_16x16x32_f16 v[128:131], v[108:111], v[76:79], v[128:131]
    v_mfma_f32_16x16x32_f16 v[132:135], v[108:111], v[92:95], v[132:135]
    ds_read_b128 v[96:99], v13 offset:0
    ds_read_b128 v[100:103], v13 offset:64
    ds_read_b128 v[104:107], v13 offset:128
    ds_read_b128 v[108:111], v13 offset:192
    v_mul_f32 v44, v56, v35
    v_mul_f32 v56, v56, v34
    v_fma_f32 v56, -v57, v35, v56
    v_fma_f32 v57, v57, v34, v44
    v_cvt_pk_f16_f32 v49, v56, -v57
    ds_write_addtid_b32 v49 offset:1632
    v_mul_f32 v45, v56, v33
    v_mul_f32 v54, v56, v32
    v_fma_f32 v54, -v57, v33, v54
    v_fma_f32 v55, v57, v32, v45
    v_cvt_pk_f16_f32 v46, v54, -v55
    ds_write_addtid_b32 v46 offset:1904
    s_mov_b32 s81, 215040
    buffer_load_dwordx4 v[200:203], v170, s[56:59], s81 offen
    v_mul_f32 v42, v56, v35
    v_mul_f32 v56, v56, v34
    v_fma_f32 v56, -v57, v35, v56
    v_fma_f32 v57, v57, v34, v42
    v_cvt_pk_f16_f32 v47, v56, -v57
    ds_write_addtid_b32 v47 offset:2176
    v_mul_f32 v43, v56, v33
    v_mul_f32 v54, v56, v32
    v_fma_f32 v54, -v57, v33, v54
    v_fma_f32 v55, v57, v32, v43
    v_cvt_pk_f16_f32 v48, v54, -v55
    ds_write_addtid_b32 v48 offset:2448
    v_mul_f32 v44, v56, v35
    v_mul_f32 v56, v56, v34
    v_fma_f32 v56, -v57, v35, v56
    v_fma_f32 v57, v57, v34, v44
    v_cvt_pk_f16_f32 v49, v56, -v57
    ds_write_addtid_b32 v49 offset:2720
    v_mul_f32 v45, v56, v33
    v_mul_f32 v54, v56, v32
    s_mov_b32 s81, 222208
    buffer_load_dwordx4 v[204:207], v170, s[56:59], s81 offen
    v_fma_f32 v54, -v57, v33, v54
    v_fma_f32 v55, v57, v32, v45
    v_cvt_pk_f16_f32 v46, v54, -v55
    ds_write_addtid_b32 v46 offset:2992
    v_mul_f32 v42, v56, v35
    v_mul_f32 v56, v56, v34
    v_fma_f32 v56, -v57, v35, v56
    v_fma_f32 v57, v57, v34, v42
    v_cvt_pk_f16_f32 v47, v56, -v57
    ds_write_addtid_b32 v47 offset:3264
    v_mul_f32 v43, v56, v33
    v_mul_f32 v54, v56, v32
    v_fma_f32 v54, -v57, v33, v54
    v_fma_f32 v55, v57, v32, v43
    v_cvt_pk_f16_f32 v48, v54, -v55
    ds_write_addtid_b32 v48 offset:3536
    s_waitcnt lgkmcnt(8)
    v_mfma_f32_16x16x32_f16 v[136:139], v[96:99], v[64:67], 0
    v_mfma_f32_16x16x32_f16 v[140:143], v[96:99], v[80:83], 0
    v_mfma_f32_16x16x32_f16 v[136:139], v[100:103], v[68:71], v[136:139]
    s_mov_b32 s81, 258048
    buffer_load_dwordx4 v[208:211], v170, s[56:59], s81 offen
    v_mfma_f32_16x16x32_f16 v[140:143], v[100:103], v[84:87], v[140:143]
    v_mfma_f32_16x16x32_f16 v[136:139], v[104:107], v[72:75], v[136:139]
    v_mfma_f32_16x16x32_f16 v[140:143], v[104:107], v[88:91], v[140:143]
    v_mfma_f32_16x16x32_f16 v[136:139], v[108:111], v[76:79], v[136:139]
    v_mfma_f32_16x16x32_f16 v[140:143], v[108:111], v[92:95], v[140:143]
    ds_read_b128 v[96:99], v14 offset:0
    ds_read_b128 v[100:103], v14 offset:64
    ds_read_b128 v[104:107], v14 offset:128
    ds_read_b128 v[108:111], v14 offset:192
    s_waitcnt lgkmcnt(0)
    v_mfma_f32_16x16x32_f16 v[144:147], v[96:99], v[64:67], 0
    v_mfma_f32_16x16x32_f16 v[148:151], v[96:99], v[80:83], 0
    v_mfma_f32_16x16x32_f16 v[144:147], v[100:103], v[68:71], v[144:147]
    v_mfma_f32_16x16x32_f16 v[148:151], v[100:103], v[84:87], v[148:151]
    v_mfma_f32_16x16x32_f16 v[144:147], v[104:107], v[72:75], v[144:147]
    v_mfma_f32_16x16x32_f16 v[148:151], v[104:107], v[88:91], v[148:151]
    v_mfma_f32_16x16x32_f16 v[144:147], v[108:111], v[76:79], v[144:147]
    v_mfma_f32_16x16x32_f16 v[148:151], v[108:111], v[92:95], v[148:151]
    ds_read_b128 v[96:99], v15 offset:0
    ds_read_b128 v[100:103], v15 offset:64
    s_mov_b32 s81, 265216
    buffer_load_dwordx4 v[212:215], v170, s[56:59], s81 offen
    ds_read_b128 v[104:107], v15 offset:128
    ds_read_b128 v[108:111], v15 offset:192
    s_waitcnt lgkmcnt(0)
    v_mfma_f32_16x16x32_f16 v[152:155], v[96:99], v[64:67], 0
    v_mfma_f32_16x16x32_f16 v[156:159], v[96:99], v[80:83], 0
    v_mfma_f32_16x16x32_f16 v[152:155], v[100:103], v[68:71], v[152:155]
    v_mfma_f32_16x16x32_f16 v[156:159], v[100:103], v[84:87], v[156:159]
    v_mfma_f32_16x16x32_f16 v[152:155], v[104:107], v[72:75], v[152:155]
    v_mfma_f32_16x16x32_f16 v[156:159], v[104:107], v[88:91], v[156:159]
    v_mfma_f32_16x16x32_f16 v[152:155], v[108:111], v[76:79], v[152:155]
    v_mfma_f32_16x16x32_f16 v[156:159], v[108:111], v[92:95], v[156:159]
    v_mul_f32 v16, 0x4138aa3b, v120
    v_mul_f32 v17, 0x3fa2f983, v121
    v_exp_f32 v16, v16
    v_fract_f32 v17, v17
    v_cos_f32 v32, v17
    v_sin_f32 v33, v17
    v_mul_f32 v32, v16, v32
    v_mul_f32 v33, v16, v33
    v_mul_f32 v16, 0x3fb8aa3b, v120
    s_mov_b32 s81, 272384
    buffer_load_dwordx4 v[216:219], v170, s[56:59], s81 offen
    v_mul_f32 v17, 0x3e22f983, v121
    v_exp_f32 v16, v16
    v_fract_f32 v17, v17
    v_cos_f32 v30, v17
    v_sin_f32 v31, v17
    v_mul_f32 v30, v16, v30
    v_mul_f32 v31, v16, v31
    v_mul_f32 v16, 0x43b8aa3b, v120
    v_mul_f32 v17, 0x4222f983, v121
    v_exp_f32 v16, v16
    v_fract_f32 v17, v17
    v_cos_f32 v34, v17
    v_sin_f32 v35, v17
    v_mul_f32 v34, v16, v34
    v_mul_f32 v35, v16, v35
    v_mul_f32 v44, v32, v33
    v_mul_f32 v40, v32, v32
    v_fma_f32 v40, -v33, v33, v40
    v_fma_f32 v41, v33, v32, v44
    v_mul_f32 v45, v30, v31
    s_mov_b32 s81, 279552
    buffer_load_dwordx4 v[220:223], v170, s[56:59], s81 offen
    v_mul_f32 v36, v30, v30
    v_fma_f32 v36, -v31, v31, v36
    v_fma_f32 v37, v31, v30, v45
    v_mul_f32 v42, v36, v37
    v_mul_f32 v38, v36, v36
    v_fma_f32 v38, -v37, v37, v38
    v_fma_f32 v39, v37, v36, v42
    v_mov_b32 v50, 1.0
    v_mov_b32 v51, 0
    v_cvt_pk_f16_f32 v49, v50, v51
    ds_write_addtid_b32 v49 offset:0
    v_cvt_pk_f16_f32 v46, v32, v33
    ds_write_addtid_b32 v46 offset:272
    v_mul_f32 v43, v32, v41
    v_mul_f32 v52, v32, v40
    v_fma_f32 v52, -v33, v41, v52
    v_fma_f32 v53, v33, v40, v43
    v_cvt_pk_f16_f32 v47, v40, v41
    ds_write_addtid_b32 v47 offset:544
    v_cvt_pk_f16_f32 v48, v52, v53
    s_mov_b32 s81, 315392
    buffer_load_dwordx4 v[224:227], v170, s[56:59], s81 offen
    ds_write_addtid_b32 v48 offset:816
    v_mul_f32 v44, v40, v41
    v_mul_f32 v50, v40, v40
    v_fma_f32 v50, -v41, v41, v50
    v_fma_f32 v51, v41, v40, v44
    v_mul_f32 v45, v52, v41
    v_mul_f32 v52, v52, v40
    v_fma_f32 v52, -v53, v41, v52
    v_fma_f32 v53, v53, v40, v45
    v_cvt_pk_f16_f32 v49, v50, v51
    ds_write_addtid_b32 v49 offset:1088
    v_cvt_pk_f16_f32 v46, v52, v53
    ds_write_addtid_b32 v46 offset:1360
    v_mul_f32 v42, v50, v41
    v_mul_f32 v50, v50, v40
    v_fma_f32 v50, -v51, v41, v50
    v_fma_f32 v51, v51, v40, v42
    v_mul_f32 v43, v52, v41
    v_mul_f32 v52, v52, v40
    v_fma_f32 v52, -v53, v41, v52
    s_mov_b32 s81, 322560
    buffer_load_dwordx4 v[228:231], v170, s[56:59], s81 offen
    v_fma_f32 v53, v53, v40, v43
    v_cvt_pk_f16_f32 v47, v50, v51
    ds_write_addtid_b32 v47 offset:1632
    v_cvt_pk_f16_f32 v48, v52, v53
    ds_write_addtid_b32 v48 offset:1904
    v_mul_f32 v44, v50, v41
    v_mul_f32 v50, v50, v40
    v_fma_f32 v50, -v51, v41, v50
    v_fma_f32 v51, v51, v40, v44
    v_mul_f32 v45, v52, v41
    v_mul_f32 v52, v52, v40
    v_fma_f32 v52, -v53, v41, v52
    v_fma_f32 v53, v53, v40, v45
    v_cvt_pk_f16_f32 v49, v50, v51
    ds_write_addtid_b32 v49 offset:2176
    v_cvt_pk_f16_f32 v46, v52, v53
    ds_write_addtid_b32 v46 offset:2448
    v_mul_f32 v42, v50, v41
    v_mul_f32 v50, v50, v40
    v_fma_f32 v50, -v51, v41, v50
    s_mov_b32 s81, 329728
    buffer_load_dwordx4 v[232:235], v170, s[56:59], s81 offen
    v_fma_f32 v51, v51, v40, v42
    v_mul_f32 v43, v52, v41
    v_mul_f32 v52, v52, v40
    v_fma_f32 v52, -v53, v41, v52
    v_fma_f32 v53, v53, v40, v43
    v_cvt_pk_f16_f32 v47, v50, v51
    ds_write_addtid_b32 v47 offset:2720
    v_cvt_pk_f16_f32 v48, v52, v53
    ds_write_addtid_b32 v48 offset:2992
    v_mul_f32 v44, v50, v41
    v_mul_f32 v50, v50, v40
    v_fma_f32 v50, -v51, v41, v50
    v_fma_f32 v51, v51, v40, v44
    v_mul_f32 v45, v52, v41
    v_mul_f32 v52, v52, v40
    v_fma_f32 v52, -v53, v41, v52
    v_fma_f32 v53, v53, v40, v45
    v_cvt_pk_f16_f32 v49, v50, v51
    ds_write_addtid_b32 v49 offset:3264
    v_cvt_pk_f16_f32 v46, v52, v53
    s_mov_b32 s81, 336896
    buffer_load_dwordx4 v[236:239], v170, s[56:59], s81 offen
    ds_write_addtid_b32 v46 offset:3536
    v_mul_f32 v42, v50, v41
    v_mul_f32 v50, v50, v40
    v_fma_f32 v50, -v51, v41, v50
    v_fma_f32 v51, v51, v40, v42
    v_mul_f32 v43, v52, v41
    v_mul_f32 v52, v52, v40
    v_fma_f32 v52, -v53, v41, v52
    v_fma_f32 v53, v53, v40, v43
    v_cvt_pk_f16_f32 v47, v50, v51
    ds_write_addtid_b32 v47 offset:3808
    v_cvt_pk_f16_f32 v48, v52, v53
    ds_write_addtid_b32 v48 offset:4080
    v_mul_f32 v44, v50, v41
    v_mul_f32 v50, v50, v40
    v_fma_f32 v50, -v51, v41, v50
    v_fma_f32 v51, v51, v40, v44
    ds_read_b128 v[64:67], v5 offset:0
    ds_read_b128 v[68:71], v5 offset:64
    ds_read_b128 v[72:75], v5 offset:128
    s_mov_b32 s81, 372736
    buffer_load_dwordx4 v[240:243], v170, s[56:59], s81 offen
    ds_read_b128 v[76:79], v5 offset:192
    v_mul_f32 v45, v52, v41
    v_mul_f32 v52, v52, v40
    v_fma_f32 v52, -v53, v41, v52
    v_fma_f32 v53, v53, v40, v45
    v_cvt_pk_f16_f32 v49, v50, v51
    ds_write_addtid_b32 v49 offset:0
    v_cvt_pk_f16_f32 v46, v52, v53
    ds_write_addtid_b32 v46 offset:272
    v_mul_f32 v42, v50, v41
    v_mul_f32 v50, v50, v40
    v_fma_f32 v50, -v51, v41, v50
    v_fma_f32 v51, v51, v40, v42
    v_mul_f32 v43, v52, v41
    v_mul_f32 v52, v52, v40
    v_fma_f32 v52, -v53, v41, v52
    v_fma_f32 v53, v53, v40, v43
    v_cvt_pk_f16_f32 v47, v50, v51
    ds_write_addtid_b32 v47 offset:544
    v_cvt_pk_f16_f32 v48, v52, v53
    s_mov_b32 s81, 379904
    buffer_load_dwordx4 v[244:247], v170, s[56:59], s81 offen
    ds_write_addtid_b32 v48 offset:816
    v_mul_f32 v44, v50, v41
    v_mul_f32 v50, v50, v40
    v_fma_f32 v50, -v51, v41, v50
    v_fma_f32 v51, v51, v40, v44
    v_mul_f32 v45, v52, v41
    v_mul_f32 v52, v52, v40
    v_fma_f32 v52, -v53, v41, v52
    v_fma_f32 v53, v53, v40, v45
    v_cvt_pk_f16_f32 v49, v50, v51
    ds_write_addtid_b32 v49 offset:1088
    v_cvt_pk_f16_f32 v46, v52, v53
    ds_write_addtid_b32 v46 offset:1360
    v_mul_f32 v42, v50, v41
    v_mul_f32 v50, v50, v40
    v_fma_f32 v50, -v51, v41, v50
    v_fma_f32 v51, v51, v40, v42
    v_mul_f32 v43, v52, v41
    v_mul_f32 v52, v52, v40
    v_fma_f32 v52, -v53, v41, v52
    s_mov_b32 s81, 387072
    buffer_load_dwordx4 v[248:251], v170, s[56:59], s81 offen
    v_fma_f32 v53, v53, v40, v43
    v_cvt_pk_f16_f32 v47, v50, v51
    ds_write_addtid_b32 v47 offset:1632
    v_cvt_pk_f16_f32 v48, v52, v53
    ds_write_addtid_b32 v48 offset:1904
    v_mul_f32 v44, v50, v41
    v_mul_f32 v50, v50, v40
    v_fma_f32 v50, -v51, v41, v50
    v_fma_f32 v51, v51, v40, v44
    v_mul_f32 v45, v52, v41
    v_mul_f32 v52, v52, v40
    v_fma_f32 v52, -v53, v41, v52
    v_fma_f32 v53, v53, v40, v45
    v_cvt_pk_f16_f32 v49, v50, v51
    ds_write_addtid_b32 v49 offset:2176
    v_cvt_pk_f16_f32 v46, v52, v53
    ds_write_addtid_b32 v46 offset:2448
    v_mul_f32 v42, v50, v41
    v_mul_f32 v50, v50, v40
    v_fma_f32 v50, -v51, v41, v50
    s_mov_b32 s81, 394240
    buffer_load_dwordx4 v[252:255], v170, s[56:59], s81 offen
    v_fma_f32 v51, v51, v40, v42
    v_mul_f32 v43, v52, v41
    v_mul_f32 v52, v52, v40
    v_fma_f32 v52, -v53, v41, v52
    v_fma_f32 v53, v53, v40, v43
    v_cvt_pk_f16_f32 v47, v50, v51
    ds_write_addtid_b32 v47 offset:2720
    v_cvt_pk_f16_f32 v48, v52, v53
    ds_write_addtid_b32 v48 offset:2992
    v_mul_f32 v44, v50, v41
    v_mul_f32 v50, v50, v40
    v_fma_f32 v50, -v51, v41, v50
    v_fma_f32 v51, v51, v40, v44
    v_mul_f32 v45, v52, v41
    v_mul_f32 v52, v52, v40
    v_fma_f32 v52, -v53, v41, v52
    v_fma_f32 v53, v53, v40, v45
    v_cvt_pk_f16_f32 v49, v50, v51
    ds_write_addtid_b32 v49 offset:3264
    v_cvt_pk_f16_f32 v46, v52, v53
    ds_write_addtid_b32 v46 offset:3536
    v_mul_f32 v42, v50, v41
    v_mul_f32 v50, v50, v40
    v_fma_f32 v50, -v51, v41, v50
    v_fma_f32 v51, v51, v40, v42
    v_mul_f32 v43, v52, v41
    v_mul_f32 v52, v52, v40
    v_fma_f32 v52, -v53, v41, v52
    v_fma_f32 v53, v53, v40, v43
    v_cvt_pk_f16_f32 v47, v50, v51
    ds_write_addtid_b32 v47 offset:3808
    v_cvt_pk_f16_f32 v48, v52, v53
    ds_write_addtid_b32 v48 offset:4080
    ds_read_b128 v[80:83], v5 offset:0
    ds_read_b128 v[84:87], v5 offset:64
    ds_read_b128 v[88:91], v5 offset:128
    ds_read_b128 v[92:95], v5 offset:192
    v_cvt_pk_f16_f32 v49, v126, -v127
    ds_write_addtid_b32 v49 offset:0
    v_mul_f32 v44, v126, v31
    v_mul_f32 v54, v126, v30
    v_fma_f32 v54, -v127, v31, v54
    v_fma_f32 v55, v127, v30, v44
    v_mul_f32 v45, v126, v35
    v_mul_f32 v56, v126, v34
    v_fma_f32 v56, -v127, v35, v56
    v_fma_f32 v57, v127, v34, v45
    v_cvt_pk_f16_f32 v46, v54, -v55
    ds_write_addtid_b32 v46 offset:272
    v_cvt_pk_f16_f32 v47, v56, -v57
    ds_write_addtid_b32 v47 offset:2176
    v_mul_f32 v42, v56, v37
    v_mul_f32 v58, v56, v36
    v_fma_f32 v58, -v57, v37, v58
    v_fma_f32 v59, v57, v36, v42
    v_mul_f32 v43, v54, v31
    v_mul_f32 v54, v54, v30
    v_fma_f32 v54, -v55, v31, v54
    v_fma_f32 v55, v55, v30, v43
    v_cvt_pk_f16_f32 v48, v54, -v55
    ds_write_addtid_b32 v48 offset:544
    v_cvt_pk_f16_f32 v49, v58, -v59
    ds_write_addtid_b32 v49 offset:2448
    v_mul_f32 v44, v58, v37
    v_mul_f32 v58, v58, v36
    v_fma_f32 v58, -v59, v37, v58
    v_fma_f32 v59, v59, v36, v44
    v_mul_f32 v45, v54, v31
    v_mul_f32 v54, v54, v30
    v_fma_f32 v54, -v55, v31, v54
    v_fma_f32 v55, v55, v30, v45
    v_cvt_pk_f16_f32 v46, v54, -v55
    ds_write_addtid_b32 v46 offset:816
    v_cvt_pk_f16_f32 v47, v58, -v59
    ds_write_addtid_b32 v47 offset:2720
    v_mul_f32 v42, v58, v37
    v_mul_f32 v58, v58, v36
    v_fma_f32 v58, -v59, v37, v58
    v_fma_f32 v59, v59, v36, v42
    v_mul_f32 v43, v54, v31
    v_mul_f32 v54, v54, v30
    v_fma_f32 v54, -v55, v31, v54
    v_fma_f32 v55, v55, v30, v43
    v_cvt_pk_f16_f32 v48, v54, -v55
    ds_write_addtid_b32 v48 offset:1088
    v_cvt_pk_f16_f32 v49, v58, -v59
    ds_write_addtid_b32 v49 offset:2992
    v_mul_f32 v44, v58, v37
    v_mul_f32 v58, v58, v36
    v_fma_f32 v58, -v59, v37, v58
    v_fma_f32 v59, v59, v36, v44
    v_mul_f32 v45, v54, v31
    v_mul_f32 v54, v54, v30
    v_fma_f32 v54, -v55, v31, v54
    v_fma_f32 v55, v55, v30, v45
    v_cvt_pk_f16_f32 v46, v54, -v55
    ds_write_addtid_b32 v46 offset:1360
    v_cvt_pk_f16_f32 v47, v58, -v59
    ds_write_addtid_b32 v47 offset:3264
    v_mul_f32 v42, v54, v31
    v_mul_f32 v54, v54, v30
    s_cmp_lg_u32 s86, 0
    s_cselect_b32 exec_lo, -1, 0
    s_mov_b32 exec_hi, 0
    buffer_load_dword v169, v112, s[52:55], 0 offen sc1
    s_mov_b64 exec, -1
    v_fma_f32 v54, -v55, v31, v54
    v_fma_f32 v55, v55, v30, v42
    v_cvt_pk_f16_f32 v48, v54, -v55
    ds_write_addtid_b32 v48 offset:1632
    v_mul_f32 v43, v54, v31
    v_mul_f32 v54, v54, v30
    v_fma_f32 v54, -v55, v31, v54
    v_fma_f32 v55, v55, v30, v43
    v_cvt_pk_f16_f32 v49, v54, -v55
    ds_write_addtid_b32 v49 offset:1904
    ds_read_b128 v[96:99], v12 offset:0
    ds_read_b128 v[100:103], v12 offset:64
    ds_read_b128 v[104:107], v12 offset:128
    ds_read_b128 v[108:111], v12 offset:192
    v_mul_f32 v44, v56, v35
    v_mul_f32 v56, v56, v34
    v_fma_f32 v56, -v57, v35, v56
    v_fma_f32 v57, v57, v34, v44
    v_cvt_pk_f16_f32 v46, v56, -v57
    ds_write_addtid_b32 v46 offset:0
    v_mul_f32 v45, v56, v39
    v_mul_f32 v58, v56, v38
    v_fma_f32 v58, -v57, v39, v58
    v_fma_f32 v59, v57, v38, v45
    v_cvt_pk_f16_f32 v47, v58, -v59
    ds_write_addtid_b32 v47 offset:272
    v_mul_f32 v42, v56, v33
    v_mul_f32 v54, v56, v32
    v_fma_f32 v54, -v57, v33, v54
    v_fma_f32 v55, v57, v32, v42
    v_cvt_pk_f16_f32 v48, v54, -v55
    ds_write_addtid_b32 v48 offset:544
    v_mul_f32 v43, v56, v35
    v_mul_f32 v56, v56, v34
    v_fma_f32 v56, -v57, v35, v56
    v_fma_f32 v57, v57, v34, v43
    v_cvt_pk_f16_f32 v49, v56, -v57
    ds_write_addtid_b32 v49 offset:816
    v_mul_f32 v44, v56, v39
    v_mul_f32 v58, v56, v38
    v_fma_f32 v58, -v57, v39, v58
    v_fma_f32 v59, v57, v38, v44
    v_cvt_pk_f16_f32 v46, v58, -v59
    ds_write_addtid_b32 v46 offset:1088
    v_mul_f32 v45, v56, v33
    v_mul_f32 v54, v56, v32
    v_fma_f32 v54, -v57, v33, v54
    v_fma_f32 v55, v57, v32, v45
    v_cvt_pk_f16_f32 v47, v54, -v55
    ds_write_addtid_b32 v47 offset:1360
    s_waitcnt lgkmcnt(6)
    v_mfma_f32_16x16x32_f16 v[128:131], v[96:99], v[64:67], v[128:131]
    v_mfma_f32_16x16x32_f16 v[132:135], v[96:99], v[80:83], v[132:135]
    v_mfma_f32_16x16x32_f16 v[128:131], v[100:103], v[68:71], v[128:131]
    v_mfma_f32_16x16x32_f16 v[132:135], v[100:103], v[84:87], v[132:135]
    v_mfma_f32_16x16x32_f16 v[128:131], v[104:107], v[72:75], v[128:131]
    v_mfma_f32_16x16x32_f16 v[132:135], v[104:107], v[88:91], v[132:135]
    v_mfma_f32_16x16x32_f16 v[128:131], v[108:111], v[76:79], v[128:131]
    v_mfma_f32_16x16x32_f16 v[132:135], v[108:111], v[92:95], v[132:135]
    ds_read_b128 v[96:99], v13 offset:0
    ds_read_b128 v[100:103], v13 offset:64
    ds_read_b128 v[104:107], v13 offset:128
    ds_read_b128 v[108:111], v13 offset:192
    v_mul_f32 v42, v56, v35
    v_mul_f32 v56, v56, v34
    v_fma_f32 v56, -v57, v35, v56
    s_cmp_eq_u32 s86, 0
    s_cbranch_scc1 UT_31
    s_waitcnt vmcnt(0)
    v_cmp_ne_u32 vcc, s84, v169
    s_nop 0
    s_cmp_lg_u32 vcc_lo, 0
    s_cbranch_scc1 UT_31
    s_mul_i32 s81, s3, 4096
    s_add_u32 s81, s81, 8388608
    s_mov_b32 m0, 132832
    s_nop 0
    buffer_load_dwordx4 v172, s[52:55], s81 offen offset:0 lds
    buffer_load_dwordx4 v172, s[52:55], s81 offen offset:1024 lds
    buffer_load_dwordx4 v172, s[52:55], s81 offen offset:2048 lds
    buffer_load_dwordx4 v172, s[52:55], s81 offen offset:3072 lds
    s_mov_b32 m0, 154080
    s_add_u32 s81, s81, 4096
    buffer_load_dwordx4 v172, s[52:55], s81 offen offset:0 lds
    buffer_load_dwordx4 v172, s[52:55], s81 offen offset:1024 lds
    buffer_load_dwordx4 v172, s[52:55], s81 offen offset:2048 lds
    buffer_load_dwordx4 v172, s[52:55], s81 offen offset:3072 lds
    s_mov_b32 m0, 158284
    s_mov_b64 exec, 1
    global_load_lds_dword v173, s[0:1]
    s_mov_b64 exec, -1
    s_mov_b32 s86, 0
    s_mov_b32 m0, s36
UT_31:
    s_nop 0
    v_fma_f32 v57, v57, v34, v42
    v_cvt_pk_f16_f32 v48, v56, -v57
    ds_write_addtid_b32 v48 offset:1632
    v_mul_f32 v43, v56, v33
    s_cmp_lg_u32 s86, 0
    s_cselect_b32 exec_lo, -1, 0
    s_mov_b32 exec_hi, 0
    buffer_load_dword v169, v112, s[52:55], 0 offen sc1
    s_mov_b64 exec, -1
    v_mul_f32 v54, v56, v32
    v_fma_f32 v54, -v57, v33, v54
    v_fma_f32 v55, v57, v32, v43
    v_cvt_pk_f16_f32 v49, v54, -v55
    ds_write_addtid_b32 v49 offset:1904
    v_mul_f32 v44, v56, v35
    v_mul_f32 v56, v56, v34
    v_fma_f32 v56, -v57, v35, v56
    v_fma_f32 v57, v57, v34, v44
    v_cvt_pk_f16_f32 v46, v56, -v57
    ds_write_addtid_b32 v46 offset:2176
    v_mul_f32 v45, v56, v33
    v_mul_f32 v54, v56, v32
    v_fma_f32 v54, -v57, v33, v54
    v_fma_f32 v55, v57, v32, v45
    v_cvt_pk_f16_f32 v47, v54, -v55
    ds_write_addtid_b32 v47 offset:2448
    v_mul_f32 v42, v56, v35
    v_mul_f32 v56, v56, v34
    v_fma_f32 v56, -v57, v35, v56
    v_fma_f32 v57, v57, v34, v42
    v_cvt_pk_f16_f32 v48, v56, -v57
    ds_write_addtid_b32 v48 offset:2720
    v_mul_f32 v43, v56, v33
    v_mul_f32 v54, v56, v32
    v_fma_f32 v54, -v57, v33, v54
    v_fma_f32 v55, v57, v32, v43
    v_cvt_pk_f16_f32 v49, v54, -v55
    ds_write_addtid_b32 v49 offset:2992
    v_mul_f32 v44, v56, v35
    v_mul_f32 v56, v56, v34
    v_fma_f32 v56, -v57, v35, v56
    v_fma_f32 v57, v57, v34, v44
    v_cvt_pk_f16_f32 v46, v56, -v57
    ds_write_addtid_b32 v46 offset:3264
    v_mul_f32 v45, v56, v33
    v_mul_f32 v54, v56, v32
    v_fma_f32 v54, -v57, v33, v54
    v_fma_f32 v55, v57, v32, v45
    v_cvt_pk_f16_f32 v47, v54, -v55
    ds_write_addtid_b32 v47 offset:3536
    s_waitcnt lgkmcnt(8)
    v_mfma_f32_16x16x32_f16 v[136:139], v[96:99], v[64:67], v[136:139]
    v_mfma_f32_16x16x32_f16 v[140:143], v[96:99], v[80:83], v[140:143]
    v_mfma_f32_16x16x32_f16 v[136:139], v[100:103], v[68:71], v[136:139]
    v_mfma_f32_16x16x32_f16 v[140:143], v[100:103], v[84:87], v[140:143]
    v_mfma_f32_16x16x32_f16 v[136:139], v[104:107], v[72:75], v[136:139]
    v_mfma_f32_16x16x32_f16 v[140:143], v[104:107], v[88:91], v[140:143]
    v_mfma_f32_16x16x32_f16 v[136:139], v[108:111], v[76:79], v[136:139]
    v_mfma_f32_16x16x32_f16 v[140:143], v[108:111], v[92:95], v[140:143]
    ds_read_b128 v[96:99], v14 offset:0
    ds_read_b128 v[100:103], v14 offset:64
    ds_read_b128 v[104:107], v14 offset:128
    ds_read_b128 v[108:111], v14 offset:192
    s_waitcnt lgkmcnt(0)
    v_mfma_f32_16x16x32_f16 v[144:147], v[96:99], v[64:67], v[144:147]
    v_mfma_f32_16x16x32_f16 v[148:151], v[96:99], v[80:83], v[148:151]
    v_mfma_f32_16x16x32_f16 v[144:147], v[100:103], v[68:71], v[144:147]
    v_mfma_f32_16x16x32_f16 v[148:151], v[100:103], v[84:87], v[148:151]
    v_mfma_f32_16x16x32_f16 v[144:147], v[104:107], v[72:75], v[144:147]
    v_mfma_f32_16x16x32_f16 v[148:151], v[104:107], v[88:91], v[148:151]
    v_mfma_f32_16x16x32_f16 v[144:147], v[108:111], v[76:79], v[144:147]
    v_mfma_f32_16x16x32_f16 v[148:151], v[108:111], v[92:95], v[148:151]
    ds_read_b128 v[96:99], v15 offset:0
    ds_read_b128 v[100:103], v15 offset:64
    ds_read_b128 v[104:107], v15 offset:128
    s_cmp_eq_u32 s86, 0
    s_cbranch_scc1 UT_32
    s_waitcnt vmcnt(0)
    v_cmp_ne_u32 vcc, s84, v169
    s_nop 0
    s_cmp_lg_u32 vcc_lo, 0
    s_cbranch_scc1 UT_32
    s_mul_i32 s81, s3, 4096
    s_add_u32 s81, s81, 8388608
    s_mov_b32 m0, 132832
    s_nop 0
    buffer_load_dwordx4 v172, s[52:55], s81 offen offset:0 lds
    buffer_load_dwordx4 v172, s[52:55], s81 offen offset:1024 lds
    buffer_load_dwordx4 v172, s[52:55], s81 offen offset:2048 lds
    buffer_load_dwordx4 v172, s[52:55], s81 offen offset:3072 lds
    s_mov_b32 m0, 154080
    s_add_u32 s81, s81, 4096
    buffer_load_dwordx4 v172, s[52:55], s81 offen offset:0 lds
    buffer_load_dwordx4 v172, s[52:55], s81 offen offset:1024 lds
    buffer_load_dwordx4 v172, s[52:55], s81 offen offset:2048 lds
    buffer_load_dwordx4 v172, s[52:55], s81 offen offset:3072 lds
    s_mov_b32 m0, 158284
    s_mov_b64 exec, 1
    global_load_lds_dword v173, s[0:1]
    s_mov_b64 exec, -1
    s_mov_b32 s86, 0
    s_mov_b32 m0, s36
UT_32:
    s_nop 0
    ds_read_b128 v[108:111], v15 offset:192
    s_waitcnt lgkmcnt(0)
    v_mfma_f32_16x16x32_f16 v[152:155], v[96:99], v[64:67], v[152:155]
    v_mfma_f32_16x16x32_f16 v[156:159], v[96:99], v[80:83], v[156:159]
    v_mfma_f32_16x16x32_f16 v[152:155], v[100:103], v[68:71], v[152:155]
    v_mfma_f32_16x16x32_f16 v[156:159], v[100:103], v[84:87], v[156:159]
    v_mfma_f32_16x16x32_f16 v[152:155], v[104:107], v[72:75], v[152:155]
    v_mfma_f32_16x16x32_f16 v[156:159], v[104:107], v[88:91], v[156:159]
    v_mfma_f32_16x16x32_f16 v[152:155], v[108:111], v[76:79], v[152:155]
    v_mfma_f32_16x16x32_f16 v[156:159], v[108:111], v[92:95], v[156:159]
    s_setprio 2
    s_cmp_lg_u32 s86, 0
    s_cselect_b32 exec_lo, -1, 0
    s_mov_b32 exec_hi, 0
    buffer_load_dword v169, v112, s[52:55], 0 offen sc1
    s_mov_b64 exec, -1
    s_cmp_lg_u32 s4, 0
    s_cbranch_scc1 X_33
    ds_write_b128 v18, v[144:147] offset:0
    ds_write_b128 v18, v[148:151] offset:1024
    ds_write_b128 v18, v[152:155] offset:2048
    ds_write_b128 v18, v[156:159] offset:3072
    s_mov_b64 exec, 1
    ds_write_b8 v161, v163 offset:24
    s_mov_b64 exec, -1
    v_add_u32 v165, 24, v162
    s_mov_b32 s83, 32768
SP_35:
    ds_read_u8 v164, v165 offset:0
    s_waitcnt lgkmcnt(0)
    v_cmp_gt_u32 vcc, 1, v164
    s_cbranch_vccz SD_36
    s_sleep 1
    s_sub_u32 s83, s83, 1
    s_cmp_lg_u32 s83, 0
    s_cbranch_scc1 SP_35
SD_36:
    ds_read_b128 v[144:147], v19 offset:0
    ds_read_b128 v[148:151], v19 offset:1024
    ds_read_b128 v[152:155], v19 offset:2048
    ds_read_b128 v[156:159], v19 offset:3072
    s_branch X_34
X_33:
    ds_write_b128 v18, v[128:131] offset:0
    ds_write_b128 v18, v[132:135] offset:1024
    ds_write_b128 v18, v[136:139] offset:2048
    ds_write_b128 v18, v[140:143] offset:3072
    s_mov_b64 exec, 1
    ds_write_b8 v161, v163 offset:24
    s_mov_b64 exec, -1
    v_add_u32 v165, 24, v162
    s_mov_b32 s83, 32768
SP_37:
    ds_read_u8 v164, v165 offset:0
    s_waitcnt lgkmcnt(0)
    v_cmp_gt_u32 vcc, 1, v164
    s_cbranch_vccz SD_38
    s_sleep 1
    s_sub_u32 s83, s83, 1
    s_cmp_lg_u32 s83, 0
    s_cbranch_scc1 SP_37
SD_38:
    ds_read_b128 v[128:131], v19 offset:0
    ds_read_b128 v[132:135], v19 offset:1024
    ds_read_b128 v[136:139], v19 offset:2048
    ds_read_b128 v[140:143], v19 offset:3072
X_34:
    ds_read_u8 v164, v118 offset:64
    s_lshl_b32 s78, s4, 11
    s_add_u32 s79, s39, s78
    s_waitcnt lgkmcnt(4)
    v_add_f32 v128, v128, v144
    v_add_f32 v129, v129, v145
    v_add_f32 v130, v130, v146
    v_add_f32 v131, v131, v147
    v_cndmask_b32 v128, v128, v129, s[16:17]
    v_cvt_pk_f16_f32 v64, v131, v130
    v_cvt_pk_f16_f32 v65, v129, v128
    s_waitcnt lgkmcnt(3)
    v_add_f32 v132, v132, v148
    v_add_f32 v133, v133, v149
    v_add_f32 v134, v134, v150
    v_add_f32 v135, v135, v151
    v_cndmask_b32 v132, v132, v133, s[16:17]
    v_cvt_pk_f16_f32 v66, v135, v134
    v_cvt_pk_f16_f32 v67, v133, v132
    s_waitcnt lgkmcnt(2)
    v_add_f32 v136, v136, v152
    v_add_f32 v137, v137, v153
    v_add_f32 v138, v138, v154
    v_add_f32 v139, v139, v155
    v_cndmask_b32 v136, v136, v137, s[16:17]
    v_cvt_pk_f16_f32 v68, v139, v138
    v_cvt_pk_f16_f32 v69, v137, v136
    s_waitcnt lgkmcnt(1)
    v_add_f32 v140, v140, v156
    v_add_f32 v141, v141, v157
    v_add_f32 v142, v142, v158
    v_add_f32 v143, v143, v159
    v_cndmask_b32 v140, v140, v141, s[16:17]
    v_cvt_pk_f16_f32 v70, v143, v142
    v_cvt_pk_f16_f32 v71, v141, v140
    s_waitcnt lgkmcnt(0)
    v_cmp_gt_u32 vcc, 10, v164
    s_cbranch_vccz XS_39
    s_mov_b32 s83, 32768
SP_40:
    ds_read_u8 v164, v118 offset:64
    s_waitcnt lgkmcnt(0)
    v_cmp_gt_u32 vcc, 10, v164
    s_cbranch_vccz SD_41
    s_sleep 4
    s_sub_u32 s83, s83, 1
    s_cmp_lg_u32 s83, 0
    s_cbranch_scc1 SP_40
SD_41:
XS_39:
    ds_write_b64 v115, v[64:65] offset:1280
    ds_write_b64 v115, v[66:67] offset:1024
    ds_write_b64 v115, v[68:69] offset:256
    ds_write_b64 v115, v[70:71] offset:0
    s_setprio 2
    s_cmp_lg_u32 s4, 0
    s_cselect_b32 exec_lo, 0, 0x3fffffff
    s_cselect_b32 exec_hi, 0, 0xffff
    ds_write_b128 v119, v[60:63]
    s_mov_b64 exec, 1
    ds_write_b8 v161, v163 offset:28
    s_mov_b64 exec, -1
    v_mov_b32 v5, v168
    s_cmp_eq_u32 s86, 0
    s_cbranch_scc1 PB_44
    s_mov_b32 s80, 32768
PB_42:
    s_waitcnt vmcnt(0)
    v_cmp_ne_u32 vcc, s84, v169
    s_nop 0
    s_cmp_eq_u32 vcc_lo, 0
    s_cbranch_scc1 PB_43
    s_sleep 20
    s_mov_b32 exec_hi, 0
    buffer_load_dword v169, v112, s[52:55], 0 offen sc1
    s_mov_b64 exec, -1
    s_sub_u32 s80, s80, 1
    s_cmp_lg_u32 s80, 0
    s_cbranch_scc1 PB_42
PB_43:
    s_mul_i32 s81, s3, 4096
    s_add_u32 s81, s81, 8388608
    s_mov_b32 m0, 132832
    s_nop 0
    buffer_load_dwordx4 v172, s[52:55], s81 offen offset:0 lds
    buffer_load_dwordx4 v172, s[52:55], s81 offen offset:1024 lds
    buffer_load_dwordx4 v172, s[52:55], s81 offen offset:2048 lds
    buffer_load_dwordx4 v172, s[52:55], s81 offen offset:3072 lds
    s_mov_b32 m0, 154080
    s_add_u32 s81, s81, 4096
    buffer_load_dwordx4 v172, s[52:55], s81 offen offset:0 lds
    buffer_load_dwordx4 v172, s[52:55], s81 offen offset:1024 lds
    buffer_load_dwordx4 v172, s[52:55], s81 offen offset:2048 lds
    buffer_load_dwordx4 v172, s[52:55], s81 offen offset:3072 lds
    s_mov_b32 m0, 158284
    s_mov_b64 exec, 1
    global_load_lds_dword v173, s[0:1]
    s_mov_b64 exec, -1
    s_mov_b32 s86, 0
PB_44:
    v_add_u32 v165, 28, v162
    s_mov_b32 s83, 32768
SP_45:
    ds_read_u8 v164, v165 offset:0
    s_waitcnt lgkmcnt(0)
    v_cmp_gt_u32 vcc, 1, v164
    s_cbranch_vccz SD_46
    s_sleep 1
    s_sub_u32 s83, s83, 1
    s_cmp_lg_u32 s83, 0
    s_cbranch_scc1 SP_45
SD_46:
    ds_read_b128 v[32:35], v5 offset:0
    ds_read_b64 v[36:37], v5 offset:16
    ds_read_b128 v[40:43], v5 offset:1024
    ds_read_b64 v[44:45], v5 offset:1040
    s_waitcnt lgkmcnt(2)
    v_alignbit_b32 v64, v33, v32, 16
    v_mov_b32 v68, v33
    v_alignbit_b32 v72, v34, v33, 16
    v_alignbit_b32 v65, v34, v33, 16
    v_mov_b32 v69, v34
    v_alignbit_b32 v73, v35, v34, 16
    v_alignbit_b32 v66, v35, v34, 16
    v_mov_b32 v70, v35
    v_alignbit_b32 v74, v36, v35, 16
    v_alignbit_b32 v67, v36, v35, 16
    v_mov_b32 v71, v36
    v_alignbit_b32 v75, v37, v36, 16
    ds_write_b128 v5, v[64:67] offset:4160
    ds_write_b128 v5, v[68:71] offset:8320
    ds_write_b128 v5, v[72:75] offset:12480
    s_waitcnt lgkmcnt(3)
    v_alignbit_b32 v76, v41, v40, 16
    v_mov_b32 v80, v41
    v_alignbit_b32 v84, v42, v41, 16
    v_alignbit_b32 v77, v42, v41, 16
    v_mov_b32 v81, v42
    v_alignbit_b32 v85, v43, v42, 16
    v_alignbit_b32 v78, v43, v42, 16
    v_mov_b32 v82, v43
    v_alignbit_b32 v86, v44, v43, 16
    v_alignbit_b32 v79, v44, v43, 16
    v_mov_b32 v83, v44
    v_alignbit_b32 v87, v45, v44, 16
    ds_write_b128 v5, v[76:79] offset:5184
    ds_write_b128 v5, v[80:83] offset:9344
    ds_write_b128 v5, v[84:87] offset:13504
    s_mov_b64 exec, 1
    ds_write_b8 v161, v163 offset:32
    s_mov_b64 exec, -1
    s_mov_b32 s83, 32768
SP_47:
    ds_read_b32 v164, v114 offset:68
    s_waitcnt lgkmcnt(0)
    v_cmp_gt_u32 vcc, 1, v164
    s_cbranch_vccz SD_48
    s_sleep 1
    s_sub_u32 s83, s83, 1
    s_cmp_lg_u32 s83, 0
    s_cbranch_scc1 SP_47
SD_48:
    ds_read_b64 v[166:167], v114 offset:8
    v_add_u32 v165, 32, v162
    s_mov_b32 s83, 32768
SP_49:
    ds_read_u8 v164, v165 offset:0
    s_waitcnt lgkmcnt(0)
    v_cmp_gt_u32 vcc, 1, v164
    s_cbranch_vccz SD_50
    s_sleep 1
    s_sub_u32 s83, s83, 1
    s_cmp_lg_u32 s83, 0
    s_cbranch_scc1 SP_49
SD_50:
    s_setprio 1
    s_mov_b32 s75, 0
    s_lshl_b32 s80, s5, 12
    v_lshl_add_u32 v156, v1, 4, s80
    v_add_u32 v158, 65536, v156
    v_lshlrev_b32 v13, 5, v2
    v_lshl_add_u32 v13, v3, 3, v13
    s_add_u32 s77, s79, 17120
    v_add_u32 v14, s77, v13
    ds_read_b64 v[128:129], v14 offset:0
    ds_read_b64 v[130:131], v14 offset:512
    ds_read_b64 v[132:133], v14 offset:1024
    ds_read_b64 v[134:135], v14 offset:1536
    ds_read_b64 v[64:65], v171 offset:4032
    ds_read_b64 v[66:67], v171 offset:4040
    ds_read_b128 v[124:127], v175 offset:4032
    ds_read_b64 v[68:69], v171 offset:3520
    ds_read_b64 v[70:71], v171 offset:3528
    ds_read_b128 v[120:123], v175 offset:3520
    ds_read_b64 v[72:73], v171 offset:3008
    ds_read_b64 v[74:75], v171 offset:3016
    ds_read_b128 v[116:119], v175 offset:3008
    ds_read_b64 v[76:77], v171 offset:2496
    ds_read_b64 v[78:79], v171 offset:2504
    ds_read_b128 v[112:115], v175 offset:2496
    ds_read_b64 v[80:81], v171 offset:1984
    ds_read_b64 v[82:83], v171 offset:1992
    ds_read_b128 v[108:111], v175 offset:1984
    ds_read_b64 v[84:85], v171 offset:1472
    ds_read_b64 v[86:87], v171 offset:1480
    ds_read_b128 v[104:107], v175 offset:1472
    ds_read_b64 v[88:89], v171 offset:960
    ds_read_b64 v[90:91], v171 offset:968
    ds_read_b128 v[100:103], v175 offset:960
    ds_read_b64 v[92:93], v171 offset:448
    ds_read_b64 v[94:95], v171 offset:456
    ds_read_b128 v[96:99], v175 offset:448
    s_waitcnt lgkmcnt(15)
    v_mfma_f32_16x16x32_f16 v[44:47], v[64:67], v[124:127], 0
    s_waitcnt lgkmcnt(15)
    v_mfma_f32_16x16x32_f16 v[40:43], v[64:67], v[120:123], 0
    s_waitcnt lgkmcnt(15)
    v_mfma_f32_16x16x32_f16 v[36:39], v[64:67], v[116:119], 0
    s_waitcnt lgkmcnt(12)
    v_mfma_f32_16x16x32_f16 v[32:35], v[64:67], v[112:115], 0
    s_waitcnt lgkmcnt(9)
    v_mfma_f32_16x16x32_f16 v[28:31], v[64:67], v[108:111], 0
    s_waitcnt lgkmcnt(6)
    v_mfma_f32_16x16x32_f16 v[24:27], v[64:67], v[104:107], 0
    s_waitcnt lgkmcnt(3)
    v_mfma_f32_16x16x32_f16 v[20:23], v[64:67], v[100:103], 0
    s_waitcnt lgkmcnt(0)
    v_mfma_f32_16x16x32_f16 v[16:19], v[64:67], v[96:99], 0
    ds_read_b64 v[64:65], v171 offset:3968
    ds_read_b64 v[66:67], v171 offset:3976
    ds_read_b128 v[124:127], v175 offset:3968
    v_mfma_f32_16x16x32_f16 v[44:47], v[68:71], v[120:123], v[44:47]
    v_lshlrev_b32 v8, 16, v160
    v_mfma_f32_16x16x32_f16 v[40:43], v[68:71], v[116:119], v[40:43]
    v_cvt_f32_f16 v136, v128
    v_mfma_f32_16x16x32_f16 v[36:39], v[68:71], v[112:115], v[36:39]
    v_lshrrev_b32 v137, 16, v128
    v_mfma_f32_16x16x32_f16 v[32:35], v[68:71], v[108:111], v[32:35]
    v_cvt_f32_f16 v137, v137
    v_mfma_f32_16x16x32_f16 v[28:31], v[68:71], v[104:107], v[28:31]
    v_mul_f32 v136, v8, v136
    v_mfma_f32_16x16x32_f16 v[24:27], v[68:71], v[100:103], v[24:27]
    v_mul_f32 v137, v8, v137
    v_mfma_f32_16x16x32_f16 v[20:23], v[68:71], v[96:99], v[20:23]
    v_cvt_pk_bf16_f32 v136, v136, v137
    ds_read_b64 v[68:69], v171 offset:3456
    ds_read_b64 v[70:71], v171 offset:3464
    ds_read_b128 v[120:123], v175 offset:3456
    v_mfma_f32_16x16x32_f16 v[44:47], v[72:75], v[116:119], v[44:47]
    v_and_b32 v137, 0xffff0000, v136
    v_mfma_f32_16x16x32_f16 v[40:43], v[72:75], v[112:115], v[40:43]
    v_lshlrev_b32 v136, 16, v136
    v_mfma_f32_16x16x32_f16 v[36:39], v[72:75], v[108:111], v[36:39]
    v_cvt_f32_f16 v138, v129
    v_mfma_f32_16x16x32_f16 v[32:35], v[72:75], v[104:107], v[32:35]
    v_lshrrev_b32 v139, 16, v129
    v_mfma_f32_16x16x32_f16 v[28:31], v[72:75], v[100:103], v[28:31]
    v_cvt_f32_f16 v139, v139
    v_mfma_f32_16x16x32_f16 v[24:27], v[72:75], v[96:99], v[24:27]
    v_mul_f32 v138, v8, v138
    ds_read_b64 v[72:73], v171 offset:2944
    ds_read_b64 v[74:75], v171 offset:2952
    ds_read_b128 v[116:119], v175 offset:2944
    v_mfma_f32_16x16x32_f16 v[44:47], v[76:79], v[112:115], v[44:47]
    v_mul_f32 v139, v8, v139
    v_mfma_f32_16x16x32_f16 v[40:43], v[76:79], v[108:111], v[40:43]
    v_cvt_pk_bf16_f32 v138, v138, v139
    v_mfma_f32_16x16x32_f16 v[36:39], v[76:79], v[104:107], v[36:39]
    v_and_b32 v139, 0xffff0000, v138
    v_mfma_f32_16x16x32_f16 v[32:35], v[76:79], v[100:103], v[32:35]
    v_lshlrev_b32 v138, 16, v138
    v_mfma_f32_16x16x32_f16 v[28:31], v[76:79], v[96:99], v[28:31]
    v_cvt_f32_f16 v140, v130
    ds_read_b64 v[76:77], v171 offset:2432
    ds_read_b64 v[78:79], v171 offset:2440
    ds_read_b128 v[112:115], v175 offset:2432
    v_mfma_f32_16x16x32_f16 v[44:47], v[80:83], v[108:111], v[44:47]
    v_lshrrev_b32 v141, 16, v130
    v_mfma_f32_16x16x32_f16 v[40:43], v[80:83], v[104:107], v[40:43]
    v_cvt_f32_f16 v141, v141
    v_mfma_f32_16x16x32_f16 v[36:39], v[80:83], v[100:103], v[36:39]
    v_mul_f32 v140, v8, v140
    v_mfma_f32_16x16x32_f16 v[32:35], v[80:83], v[96:99], v[32:35]
    v_mul_f32 v141, v8, v141
    ds_read_b64 v[80:81], v171 offset:1920
    ds_read_b64 v[82:83], v171 offset:1928
    ds_read_b128 v[108:111], v175 offset:1920
    v_mfma_f32_16x16x32_f16 v[44:47], v[84:87], v[104:107], v[44:47]
    v_cvt_pk_bf16_f32 v140, v140, v141
    v_mfma_f32_16x16x32_f16 v[40:43], v[84:87], v[100:103], v[40:43]
    v_and_b32 v141, 0xffff0000, v140
    v_mfma_f32_16x16x32_f16 v[36:39], v[84:87], v[96:99], v[36:39]
    v_lshlrev_b32 v140, 16, v140
    ds_read_b64 v[84:85], v171 offset:1408
    ds_read_b64 v[86:87], v171 offset:1416
    ds_read_b128 v[104:107], v175 offset:1408
    v_mfma_f32_16x16x32_f16 v[44:47], v[88:91], v[100:103], v[44:47]
    v_cvt_f32_f16 v142, v131
    v_mfma_f32_16x16x32_f16 v[40:43], v[88:91], v[96:99], v[40:43]
    v_lshrrev_b32 v143, 16, v131
    ds_read_b64 v[88:89], v171 offset:896
    ds_read_b64 v[90:91], v171 offset:904
    ds_read_b128 v[100:103], v175 offset:896
    v_mfma_f32_16x16x32_f16 v[44:47], v[92:95], v[96:99], v[44:47]
    v_cvt_f32_f16 v143, v143
    ds_read_b64 v[92:93], v171 offset:384
    ds_read_b64 v[94:95], v171 offset:392
    ds_read_b128 v[96:99], v175 offset:384
    s_waitcnt lgkmcnt(15)
    v_mfma_f32_16x16x32_f16 v[44:47], v[64:67], v[124:127], v[44:47]
    v_mul_f32 v142, v8, v142
    s_waitcnt lgkmcnt(15)
    v_mfma_f32_16x16x32_f16 v[40:43], v[64:67], v[120:123], v[40:43]
    v_mul_f32 v143, v8, v143
    s_waitcnt lgkmcnt(15)
    v_mfma_f32_16x16x32_f16 v[36:39], v[64:67], v[116:119], v[36:39]
    v_cvt_pk_bf16_f32 v142, v142, v143
    s_waitcnt lgkmcnt(12)
    v_mfma_f32_16x16x32_f16 v[32:35], v[64:67], v[112:115], v[32:35]
    v_and_b32 v143, 0xffff0000, v142
    s_waitcnt lgkmcnt(9)
    v_mfma_f32_16x16x32_f16 v[28:31], v[64:67], v[108:111], v[28:31]
    v_lshlrev_b32 v142, 16, v142
    s_waitcnt lgkmcnt(6)
    v_mfma_f32_16x16x32_f16 v[24:27], v[64:67], v[104:107], v[24:27]
    v_cvt_f32_f16 v144, v132
    s_waitcnt lgkmcnt(3)
    v_mfma_f32_16x16x32_f16 v[20:23], v[64:67], v[100:103], v[20:23]
    v_lshrrev_b32 v145, 16, v132
    s_waitcnt lgkmcnt(0)
    v_mfma_f32_16x16x32_f16 v[16:19], v[64:67], v[96:99], v[16:19]
    v_cvt_f32_f16 v145, v145
    ds_read_b64 v[64:65], v171 offset:3904
    ds_read_b64 v[66:67], v171 offset:3912
    ds_read_b128 v[124:127], v175 offset:3904
    v_mfma_f32_16x16x32_f16 v[44:47], v[68:71], v[120:123], v[44:47]
    v_mul_f32 v144, v8, v144
    v_mfma_f32_16x16x32_f16 v[40:43], v[68:71], v[116:119], v[40:43]
    v_mul_f32 v145, v8, v145
    v_mfma_f32_16x16x32_f16 v[36:39], v[68:71], v[112:115], v[36:39]
    v_cvt_pk_bf16_f32 v144, v144, v145
    v_mfma_f32_16x16x32_f16 v[32:35], v[68:71], v[108:111], v[32:35]
    v_and_b32 v145, 0xffff0000, v144
    v_mfma_f32_16x16x32_f16 v[28:31], v[68:71], v[104:107], v[28:31]
    v_lshlrev_b32 v144, 16, v144
    v_mfma_f32_16x16x32_f16 v[24:27], v[68:71], v[100:103], v[24:27]
    v_cvt_f32_f16 v146, v133
    v_mfma_f32_16x16x32_f16 v[20:23], v[68:71], v[96:99], v[20:23]
    v_lshrrev_b32 v147, 16, v133
    ds_read_b64 v[68:69], v171 offset:3392
    ds_read_b64 v[70:71], v171 offset:3400
    ds_read_b128 v[120:123], v175 offset:3392
    v_mfma_f32_16x16x32_f16 v[44:47], v[72:75], v[116:119], v[44:47]
    v_cvt_f32_f16 v147, v147
    v_mfma_f32_16x16x32_f16 v[40:43], v[72:75], v[112:115], v[40:43]
    v_mul_f32 v146, v8, v146
    v_mfma_f32_16x16x32_f16 v[36:39], v[72:75], v[108:111], v[36:39]
    v_mul_f32 v147, v8, v147
    v_mfma_f32_16x16x32_f16 v[32:35], v[72:75], v[104:107], v[32:35]
    v_cvt_pk_bf16_f32 v146, v146, v147
    v_mfma_f32_16x16x32_f16 v[28:31], v[72:75], v[100:103], v[28:31]
    v_and_b32 v147, 0xffff0000, v146
    v_mfma_f32_16x16x32_f16 v[24:27], v[72:75], v[96:99], v[24:27]
    v_lshlrev_b32 v146, 16, v146
    ds_read_b64 v[72:73], v171 offset:2880
    ds_read_b64 v[74:75], v171 offset:2888
    ds_read_b128 v[116:119], v175 offset:2880
    v_mfma_f32_16x16x32_f16 v[44:47], v[76:79], v[112:115], v[44:47]
    v_cvt_f32_f16 v148, v134
    v_mfma_f32_16x16x32_f16 v[40:43], v[76:79], v[108:111], v[40:43]
    v_lshrrev_b32 v149, 16, v134
    v_mfma_f32_16x16x32_f16 v[36:39], v[76:79], v[104:107], v[36:39]
    v_cvt_f32_f16 v149, v149
    v_mfma_f32_16x16x32_f16 v[32:35], v[76:79], v[100:103], v[32:35]
    v_mul_f32 v148, v8, v148
    v_mfma_f32_16x16x32_f16 v[28:31], v[76:79], v[96:99], v[28:31]
    v_mul_f32 v149, v8, v149
    ds_read_b64 v[76:77], v171 offset:2368
    ds_read_b64 v[78:79], v171 offset:2376
    ds_read_b128 v[112:115], v175 offset:2368
    v_mfma_f32_16x16x32_f16 v[44:47], v[80:83], v[108:111], v[44:47]
    v_cvt_pk_bf16_f32 v148, v148, v149
    v_mfma_f32_16x16x32_f16 v[40:43], v[80:83], v[104:107], v[40:43]
    v_and_b32 v149, 0xffff0000, v148
    v_mfma_f32_16x16x32_f16 v[36:39], v[80:83], v[100:103], v[36:39]
    v_lshlrev_b32 v148, 16, v148
    v_mfma_f32_16x16x32_f16 v[32:35], v[80:83], v[96:99], v[32:35]
    v_cvt_f32_f16 v150, v135
    ds_read_b64 v[80:81], v171 offset:1856
    ds_read_b64 v[82:83], v171 offset:1864
    ds_read_b128 v[108:111], v175 offset:1856
    v_mfma_f32_16x16x32_f16 v[44:47], v[84:87], v[104:107], v[44:47]
    v_lshrrev_b32 v151, 16, v135
    v_mfma_f32_16x16x32_f16 v[40:43], v[84:87], v[100:103], v[40:43]
    v_cvt_f32_f16 v151, v151
    v_mfma_f32_16x16x32_f16 v[36:39], v[84:87], v[96:99], v[36:39]
    v_mul_f32 v150, v8, v150
    ds_read_b64 v[84:85], v171 offset:1344
    ds_read_b64 v[86:87], v171 offset:1352
    ds_read_b128 v[104:107], v175 offset:1344
    v_mfma_f32_16x16x32_f16 v[44:47], v[88:91], v[100:103], v[44:47]
    v_mul_f32 v151, v8, v151
    v_mfma_f32_16x16x32_f16 v[40:43], v[88:91], v[96:99], v[40:43]
    v_cvt_pk_bf16_f32 v150, v150, v151
    ds_read_b64 v[88:89], v171 offset:832
    ds_read_b64 v[90:91], v171 offset:840
    ds_read_b128 v[100:103], v175 offset:832
    v_mfma_f32_16x16x32_f16 v[44:47], v[92:95], v[96:99], v[44:47]
    v_and_b32 v151, 0xffff0000, v150
    ds_read_b64 v[92:93], v171 offset:320
    ds_read_b64 v[94:95], v171 offset:328
    ds_read_b128 v[96:99], v175 offset:320
    s_waitcnt lgkmcnt(15)
    v_mfma_f32_16x16x32_f16 v[44:47], v[64:67], v[124:127], v[44:47]
    v_lshlrev_b32 v150, 16, v150
    s_waitcnt lgkmcnt(15)
    v_mfma_f32_16x16x32_f16 v[40:43], v[64:67], v[120:123], v[40:43]
    v_lshl_add_u32 v5, v1, 4, s36
    s_xor_b32 s76, s5, 1
    s_mul_i32 s76, s76, 4352
    s_add_u32 s76, s76, 98304
    s_waitcnt lgkmcnt(15)
    v_mfma_f32_16x16x32_f16 v[36:39], v[64:67], v[116:119], v[36:39]
    v_lshl_add_u32 v152, v1, 4, s76
    s_waitcnt lgkmcnt(12)
    v_mfma_f32_16x16x32_f16 v[32:35], v[64:67], v[112:115], v[32:35]
    v_and_b32 v13, 1, v3
    s_waitcnt lgkmcnt(9)
    v_mfma_f32_16x16x32_f16 v[28:31], v[64:67], v[108:111], v[28:31]
    v_lshlrev_b32 v13, 9, v13
    s_waitcnt lgkmcnt(6)
    v_mfma_f32_16x16x32_f16 v[24:27], v[64:67], v[104:107], v[24:27]
    v_lshrrev_b32 v14, 2, v2
    s_waitcnt lgkmcnt(3)
    v_mfma_f32_16x16x32_f16 v[20:23], v[64:67], v[100:103], v[20:23]
    v_lshl_add_u32 v13, v14, 7, v13
    s_waitcnt lgkmcnt(0)
    v_mfma_f32_16x16x32_f16 v[16:19], v[64:67], v[96:99], v[16:19]
    v_lshrrev_b32 v14, 1, v3
    ds_read_b64 v[64:65], v171 offset:3840
    ds_read_b64 v[66:67], v171 offset:3848
    ds_read_b128 v[124:127], v175 offset:3840
    v_mfma_f32_16x16x32_f16 v[44:47], v[68:71], v[120:123], v[44:47]
    v_lshl_add_u32 v13, v14, 6, v13
    v_mfma_f32_16x16x32_f16 v[40:43], v[68:71], v[116:119], v[40:43]
    v_and_b32 v14, 3, v2
    v_mfma_f32_16x16x32_f16 v[36:39], v[68:71], v[112:115], v[36:39]
    v_lshl_add_u32 v13, v14, 4, v13
    v_mfma_f32_16x16x32_f16 v[32:35], v[68:71], v[108:111], v[32:35]
    v_add_u32 v13, s78, v13
    s_and_b32 s76, s3, 0xfffe
    s_add_u32 s76, s76, s4
    s_lshl_b32 s76, s76, 8
    s_and_b32 s77, s3, 1
    s_lshl_b32 s77, s77, 3
    s_add_u32 s76, s76, s77
    s_add_u32 s76, s76, 7602176
    v_mfma_f32_16x16x32_f16 v[28:31], v[68:71], v[104:107], v[28:31]
    v_mov_b32 v14, s76
    v_mfma_f32_16x16x32_f16 v[24:27], v[68:71], v[100:103], v[24:27]
    v_readfirstlane_b32 s84, v166
    v_mfma_f32_16x16x32_f16 v[20:23], v[68:71], v[96:99], v[20:23]
    v_readfirstlane_b32 s85, v167
    s_lshl_b32 s76, s74, 14
    s_lshl_b32 s77, s5, 12
    s_add_u32 s76, s76, s77
    s_lshr_b32 s77, s73, 4
    s_lshl_b32 s77, s77, 8
    s_add_u32 s76, s76, s77
    s_add_u32 s76, s76, 7602176
    ds_read_b64 v[68:69], v171 offset:3328
    ds_read_b64 v[70:71], v171 offset:3336
    ds_read_b128 v[120:123], v175 offset:3328
    v_mfma_f32_16x16x32_f16 v[44:47], v[72:75], v[116:119], v[44:47]
    v_lshrrev_b32 v153, 1, v2
    v_mfma_f32_16x16x32_f16 v[40:43], v[72:75], v[112:115], v[40:43]
    v_lshl_add_u32 v153, v153, 9, s76
    v_mfma_f32_16x16x32_f16 v[36:39], v[72:75], v[108:111], v[36:39]
    v_and_b32 v154, 1, v2
    v_mfma_f32_16x16x32_f16 v[32:35], v[72:75], v[104:107], v[32:35]
    v_lshl_add_u32 v153, v154, 3, v153
    s_lshl_b32 s76, s5, 4
    v_mfma_f32_16x16x32_f16 v[28:31], v[72:75], v[100:103], v[28:31]
    v_lshrrev_b32 v154, 3, v1
    v_mfma_f32_16x16x32_f16 v[24:27], v[72:75], v[96:99], v[24:27]
    v_add_u32 v154, s76, v154
    s_lshl_b32 s76, s74, 6
    ds_read_b64 v[72:73], v171 offset:2816
    ds_read_b64 v[74:75], v171 offset:2824
    ds_read_b128 v[116:119], v175 offset:2816
    v_mfma_f32_16x16x32_f16 v[44:47], v[76:79], v[112:115], v[44:47]
    v_add_u32 v154, s76, v154
    v_mfma_f32_16x16x32_f16 v[40:43], v[76:79], v[108:111], v[40:43]
    v_mul_u32_u24 v154, 4096, v154
    v_mfma_f32_16x16x32_f16 v[36:39], v[76:79], v[104:107], v[36:39]
    v_and_b32 v155, 7, v1
    v_mfma_f32_16x16x32_f16 v[32:35], v[76:79], v[100:103], v[32:35]
    v_lshl_add_u32 v154, v155, 4, v154
    s_lshl_b32 s78, s73, 7
    s_add_u32 s78, s78, 8388608
    s_add_u32 s79, s78, 32768
    s_mul_i32 s76, s3, 4096
    s_add_u32 s76, s76, 8388608
    v_mfma_f32_16x16x32_f16 v[28:31], v[76:79], v[96:99], v[28:31]
    v_add_u32 v165, 36, v162
    s_lshl_b32 s80, s4, 13
    s_add_u32 s80, s80, s39
    ds_read_b64 v[76:77], v171 offset:2304
    ds_read_b64 v[78:79], v171 offset:2312
    ds_read_b128 v[112:115], v175 offset:2304
    v_mfma_f32_16x16x32_f16 v[44:47], v[80:83], v[108:111], v[44:47]
    v_lshl_add_u32 v157, v1, 4, s80
    v_mfma_f32_16x16x32_f16 v[40:43], v[80:83], v[104:107], v[40:43]
    v_mfma_f32_16x16x32_f16 v[36:39], v[80:83], v[100:103], v[36:39]
    v_mfma_f32_16x16x32_f16 v[32:35], v[80:83], v[96:99], v[32:35]
    ds_read_b64 v[80:81], v171 offset:1792
    ds_read_b64 v[82:83], v171 offset:1800
    ds_read_b128 v[108:111], v175 offset:1792
    v_mfma_f32_16x16x32_f16 v[44:47], v[84:87], v[104:107], v[44:47]
    v_mfma_f32_16x16x32_f16 v[40:43], v[84:87], v[100:103], v[40:43]
    v_mfma_f32_16x16x32_f16 v[36:39], v[84:87], v[96:99], v[36:39]
    ds_read_b64 v[84:85], v171 offset:1280
    ds_read_b64 v[86:87], v171 offset:1288
    ds_read_b128 v[104:107], v175 offset:1280
    v_mfma_f32_16x16x32_f16 v[44:47], v[88:91], v[100:103], v[44:47]
    v_mfma_f32_16x16x32_f16 v[40:43], v[88:91], v[96:99], v[40:43]
    ds_read_b64 v[88:89], v171 offset:768
    ds_read_b64 v[90:91], v171 offset:776
    ds_read_b128 v[100:103], v175 offset:768
    v_mfma_f32_16x16x32_f16 v[44:47], v[92:95], v[96:99], v[44:47]
    ds_read_b64 v[92:93], v171 offset:256
    ds_read_b64 v[94:95], v171 offset:264
    ds_read_b128 v[96:99], v175 offset:256
    s_waitcnt lgkmcnt(15)
    v_mfma_f32_16x16x32_f16 v[44:47], v[64:67], v[124:127], v[44:47]
    s_waitcnt lgkmcnt(15)
    v_mfma_f32_16x16x32_f16 v[40:43], v[64:67], v[120:123], v[40:43]
    s_waitcnt lgkmcnt(15)
    v_mfma_f32_16x16x32_f16 v[36:39], v[64:67], v[116:119], v[36:39]
    s_waitcnt lgkmcnt(12)
    v_mfma_f32_16x16x32_f16 v[32:35], v[64:67], v[112:115], v[32:35]
    s_waitcnt lgkmcnt(9)
    v_mfma_f32_16x16x32_f16 v[28:31], v[64:67], v[108:111], v[28:31]
    s_waitcnt lgkmcnt(6)
    v_mfma_f32_16x16x32_f16 v[24:27], v[64:67], v[104:107], v[24:27]
    s_waitcnt lgkmcnt(3)
    v_mfma_f32_16x16x32_f16 v[20:23], v[64:67], v[100:103], v[20:23]
    s_waitcnt lgkmcnt(0)
    v_mfma_f32_16x16x32_f16 v[16:19], v[64:67], v[96:99], v[16:19]
    v_mfma_f32_16x16x32_f16 v[44:47], v[68:71], v[120:123], v[44:47]
    v_mfma_f32_16x16x32_f16 v[40:43], v[68:71], v[116:119], v[40:43]
    v_mfma_f32_16x16x32_f16 v[36:39], v[68:71], v[112:115], v[36:39]
    v_mfma_f32_16x16x32_f16 v[32:35], v[68:71], v[108:111], v[32:35]
    v_mfma_f32_16x16x32_f16 v[28:31], v[68:71], v[104:107], v[28:31]
    v_mfma_f32_16x16x32_f16 v[24:27], v[68:71], v[100:103], v[24:27]
    v_mfma_f32_16x16x32_f16 v[20:23], v[68:71], v[96:99], v[20:23]
    v_mfma_f32_16x16x32_f16 v[44:47], v[72:75], v[116:119], v[44:47]
    v_mfma_f32_16x16x32_f16 v[40:43], v[72:75], v[112:115], v[40:43]
    v_mfma_f32_16x16x32_f16 v[36:39], v[72:75], v[108:111], v[36:39]
    v_mfma_f32_16x16x32_f16 v[32:35], v[72:75], v[104:107], v[32:35]
    v_mfma_f32_16x16x32_f16 v[28:31], v[72:75], v[100:103], v[28:31]
    v_mfma_f32_16x16x32_f16 v[24:27], v[72:75], v[96:99], v[24:27]
    v_mfma_f32_16x16x32_f16 v[44:47], v[76:79], v[112:115], v[44:47]
    v_mfma_f32_16x16x32_f16 v[40:43], v[76:79], v[108:111], v[40:43]
    v_mfma_f32_16x16x32_f16 v[36:39], v[76:79], v[104:107], v[36:39]
    v_mfma_f32_16x16x32_f16 v[32:35], v[76:79], v[100:103], v[32:35]
    v_mfma_f32_16x16x32_f16 v[28:31], v[76:79], v[96:99], v[28:31]
    v_mfma_f32_16x16x32_f16 v[44:47], v[80:83], v[108:111], v[44:47]
    v_mfma_f32_16x16x32_f16 v[40:43], v[80:83], v[104:107], v[40:43]
    v_mfma_f32_16x16x32_f16 v[36:39], v[80:83], v[100:103], v[36:39]
    v_mfma_f32_16x16x32_f16 v[32:35], v[80:83], v[96:99], v[32:35]
    v_mfma_f32_16x16x32_f16 v[44:47], v[84:87], v[104:107], v[44:47]
    v_mfma_f32_16x16x32_f16 v[40:43], v[84:87], v[100:103], v[40:43]
    v_mfma_f32_16x16x32_f16 v[36:39], v[84:87], v[96:99], v[36:39]
    v_mfma_f32_16x16x32_f16 v[44:47], v[88:91], v[100:103], v[44:47]
    v_mfma_f32_16x16x32_f16 v[40:43], v[88:91], v[96:99], v[40:43]
    v_mfma_f32_16x16x32_f16 v[44:47], v[92:95], v[96:99], v[44:47]
    s_setprio 3
    s_cmp_lg_u32 s4, 0
    s_cbranch_scc1 X_51
    ds_write_b128 v5, v[32:35] offset:0
    s_nop 0
    ds_write_b128 v5, v[36:39] offset:1024
    s_nop 0
    ds_write_b128 v5, v[40:43] offset:2048
    ds_write_b128 v5, v[44:47] offset:3072
    s_mov_b64 exec, 1
    ds_write_b8 v161, v163 offset:36
    s_mov_b64 exec, -1
    s_branch X_52
X_51:
    ds_write_b128 v5, v[16:19] offset:0
    ds_write_b128 v5, v[20:23] offset:1024
    ds_write_b128 v5, v[24:27] offset:2048
    ds_write_b128 v5, v[28:31] offset:3072
    s_mov_b64 exec, 1
    ds_write_b8 v161, v163 offset:36
    s_mov_b64 exec, -1
    v_mov_b32 v16, v32
    v_mov_b32 v17, v33
    v_mov_b32 v18, v34
    v_mov_b32 v19, v35
    v_mov_b32 v20, v36
    v_mov_b32 v21, v37
    v_mov_b32 v22, v38
    v_mov_b32 v23, v39
    v_mov_b32 v24, v40
    v_mov_b32 v25, v41
    v_mov_b32 v26, v42
    v_mov_b32 v27, v43
    v_mov_b32 v28, v44
    v_mov_b32 v29, v45
    v_mov_b32 v30, v46
    v_mov_b32 v31, v47
X_52:
    s_mov_b32 s83, 32768
SP_53:
    ds_read_u8 v164, v165 offset:0
    s_waitcnt lgkmcnt(0)
    v_cmp_gt_u32 vcc, 1, v164
    s_cbranch_vccz SD_54
    s_sub_u32 s83, s83, 1
    s_cmp_lg_u32 s83, 0
    s_cbranch_scc1 SP_53
SD_54:
    ds_read_b128 v[32:35], v152 offset:0
    ds_read_b128 v[36:39], v152 offset:1024
    ds_read_b128 v[40:43], v152 offset:2048
    ds_read_b128 v[44:47], v152 offset:3072
    s_waitcnt lgkmcnt(3)
    v_add_f32 v16, v16, v32
    v_add_f32 v17, v17, v33
    v_mul_f32 v16, s7, v16
    v_mul_f32 v17, s7, v17
    v_cvt_pk_bf16_f32 v16, v16, v17
    v_and_b32 v17, 0xffff0000, v16
    v_lshlrev_b32 v16, 16, v16
    v_add_f32 v16, v16, v136
    v_add_f32 v17, v17, v137
    v_cvt_pk_bf16_f32 v72, v16, v17
    v_add_f32 v18, v18, v34
    v_add_f32 v19, v19, v35
    v_mul_f32 v18, s7, v18
    v_mul_f32 v19, s7, v19
    v_cvt_pk_bf16_f32 v18, v18, v19
    v_and_b32 v19, 0xffff0000, v18
    v_lshlrev_b32 v18, 16, v18
    v_add_f32 v18, v18, v138
    v_add_f32 v19, v19, v139
    v_cvt_pk_bf16_f32 v73, v18, v19
    s_waitcnt lgkmcnt(2)
    v_add_f32 v20, v20, v36
    v_add_f32 v21, v21, v37
    v_mul_f32 v20, s7, v20
    v_mul_f32 v21, s7, v21
    v_cvt_pk_bf16_f32 v20, v20, v21
    v_and_b32 v21, 0xffff0000, v20
    v_lshlrev_b32 v20, 16, v20
    v_add_f32 v20, v20, v140
    v_add_f32 v21, v21, v141
    v_cvt_pk_bf16_f32 v74, v20, v21
    v_add_f32 v22, v22, v38
    v_add_f32 v23, v23, v39
    v_mul_f32 v22, s7, v22
    v_mul_f32 v23, s7, v23
    v_cvt_pk_bf16_f32 v22, v22, v23
    v_and_b32 v23, 0xffff0000, v22
    v_lshlrev_b32 v22, 16, v22
    v_add_f32 v22, v22, v142
    v_add_f32 v23, v23, v143
    v_cvt_pk_bf16_f32 v75, v22, v23
    v_permlane16_swap_b32 v72, v74
    s_nop 0
    v_permlane16_swap_b32 v73, v75
    buffer_store_dwordx4 v[72:75], v13, s[52:55], s76 offen offset:0 sc1
    s_waitcnt lgkmcnt(1)
    v_add_f32 v24, v24, v40
    v_add_f32 v25, v25, v41
    v_mul_f32 v24, s7, v24
    v_mul_f32 v25, s7, v25
    v_cvt_pk_bf16_f32 v24, v24, v25
    v_and_b32 v25, 0xffff0000, v24
    v_lshlrev_b32 v24, 16, v24
    v_add_f32 v24, v24, v144
    v_add_f32 v25, v25, v145
    v_cvt_pk_bf16_f32 v76, v24, v25
    v_add_f32 v26, v26, v42
    v_add_f32 v27, v27, v43
    v_mul_f32 v26, s7, v26
    v_mul_f32 v27, s7, v27
    v_cvt_pk_bf16_f32 v26, v26, v27
    v_and_b32 v27, 0xffff0000, v26
    v_lshlrev_b32 v26, 16, v26
    v_add_f32 v26, v26, v146
    v_add_f32 v27, v27, v147
    v_cvt_pk_bf16_f32 v77, v26, v27
    s_waitcnt lgkmcnt(0)
    v_add_f32 v28, v28, v44
    v_add_f32 v29, v29, v45
    v_mul_f32 v28, s7, v28
    v_mul_f32 v29, s7, v29
    v_cvt_pk_bf16_f32 v28, v28, v29
    v_and_b32 v29, 0xffff0000, v28
    v_lshlrev_b32 v28, 16, v28
    v_add_f32 v28, v28, v148
    v_add_f32 v29, v29, v149
    v_cvt_pk_bf16_f32 v78, v28, v29
    v_add_f32 v30, v30, v46
    v_add_f32 v31, v31, v47
    v_mul_f32 v30, s7, v30
    v_mul_f32 v31, s7, v31
    v_cvt_pk_bf16_f32 v30, v30, v31
    v_and_b32 v31, 0xffff0000, v30
    v_lshlrev_b32 v30, 16, v30
    v_add_f32 v30, v30, v150
    v_add_f32 v31, v31, v151
    v_cvt_pk_bf16_f32 v79, v30, v31
    v_permlane16_swap_b32 v76, v78
    s_nop 0
    v_permlane16_swap_b32 v77, v79
    buffer_store_dwordx4 v[76:79], v13, s[52:55], s76 offen offset:1024 sc1
    s_mov_b64 exec, 1
    ds_write_b8 v161, v163 offset:40
    s_mov_b64 exec, -1
    ds_read_u8 v164, v161 offset:68
    s_waitcnt vmcnt(2) lgkmcnt(0)
    v_cmp_gt_u32 vcc, 1, v164
    s_cbranch_vccnz CO_55
    s_mov_b32 s75, 1
    ds_write_b128 v156, v[176:179] offset:0
    s_nop 7
    ds_write_b128 v156, v[180:183] offset:1024
    s_nop 7
    ds_write_b128 v156, v[184:187] offset:2048
    s_nop 7
    ds_write_b128 v156, v[188:191] offset:3072
    s_nop 7
    ds_write_b128 v156, v[192:195] offset:16384
    s_nop 7
    ds_write_b128 v156, v[196:199] offset:17408
    s_nop 7
    ds_write_b128 v156, v[200:203] offset:18432
    s_nop 7
    ds_write_b128 v156, v[204:207] offset:19456
    s_nop 7
    ds_write_b128 v158, v[208:211] offset:0
    s_nop 7
    ds_write_b128 v158, v[212:215] offset:1024
    s_nop 7
    ds_write_b128 v158, v[216:219] offset:2048
    s_nop 7
    ds_write_b128 v158, v[220:223] offset:3072
    s_nop 7
    v_mov_b32 v159, 1
    s_mov_b64 exec, 1
    ds_write_b8 v161, v159 offset:72
    s_mov_b64 exec, -1
CO_55:
    s_waitcnt vmcnt(0)
    s_mov_b64 exec, 1
    buffer_store_dwordx2 v[166:167], v14, s[52:55], 0 offen sc1
    s_mov_b64 exec, -1
    s_mov_b32 s83, 32768
SP_56:
    ds_read_u8 v164, v161 offset:68
    s_waitcnt lgkmcnt(0)
    v_cmp_gt_u32 vcc, 1, v164
    s_cbranch_vccz SD_57
    s_sleep 1
    s_sub_u32 s83, s83, 1
    s_cmp_lg_u32 s83, 0
    s_cbranch_scc1 SP_56
SD_57:
    s_cmp_lg_u32 s75, 0
    s_cbranch_scc1 CA_58
    ds_write_b128 v156, v[176:179] offset:0
    s_nop 7
    ds_write_b128 v156, v[180:183] offset:1024
    s_nop 7
    ds_write_b128 v156, v[184:187] offset:2048
    s_nop 7
    ds_write_b128 v156, v[188:191] offset:3072
    s_nop 7
    ds_write_b128 v156, v[192:195] offset:16384
    s_nop 7
    ds_write_b128 v156, v[196:199] offset:17408
    s_nop 7
    ds_write_b128 v156, v[200:203] offset:18432
    s_nop 7
    ds_write_b128 v156, v[204:207] offset:19456
    s_nop 7
    ds_write_b128 v158, v[208:211] offset:0
    s_nop 7
    ds_write_b128 v158, v[212:215] offset:1024
    s_nop 7
    ds_write_b128 v158, v[216:219] offset:2048
    s_nop 7
    ds_write_b128 v158, v[220:223] offset:3072
    s_nop 7
    v_mov_b32 v159, 1
    s_mov_b64 exec, 1
    ds_write_b8 v161, v159 offset:72
    s_mov_b64 exec, -1
CA_58:
    ds_write_b128 v157, v[224:227] offset:0
    s_nop 7
    s_nop 7
    ds_write_b128 v157, v[228:231] offset:1024
    s_nop 7
    s_nop 7
    ds_write_b128 v157, v[232:235] offset:2048
    s_nop 7
    s_nop 7
    ds_write_b128 v157, v[236:239] offset:3072
    s_nop 7
    s_nop 7
    ds_write_b128 v157, v[240:243] offset:4096
    s_nop 7
    s_nop 7
    ds_write_b128 v157, v[244:247] offset:5120
    s_nop 7
    s_nop 7
    ds_write_b128 v157, v[248:251] offset:6144
    s_nop 7
    s_nop 7
    ds_write_b128 v157, v[252:255] offset:7168
    s_nop 7
    s_nop 7
    v_mov_b32 v159, 2
    s_mov_b64 exec, 1
    ds_write_b8 v161, v159 offset:72
    s_mov_b64 exec, -1
    s_setprio 0
    s_sleep 8
    s_mov_b32 s80, 32768
CP_59:
    s_mov_b64 exec, 0xffff
    buffer_load_dwordx2 v[20:21], v153, s[52:55], 0 offen sc1
    s_waitcnt vmcnt(0)
    v_cmp_ne_u64 vcc, s[84:85], v[20:21]
    s_mov_b64 exec, -1
    s_cbranch_vccz CP_60
    s_sleep 8
    s_sub_u32 s80, s80, 1
    s_cmp_lg_u32 s80, 0
    s_cbranch_scc1 CP_59
CP_60:
    buffer_load_dwordx4 v[104:107], v154, s[52:55], s78 offen sc1
    buffer_load_dwordx4 v[108:111], v154, s[52:55], s79 offen sc1
    v_add_u32 v165, 40, v162
    s_mov_b32 s83, 32768
SP_61:
    ds_read_u8 v164, v165 offset:0
    s_waitcnt lgkmcnt(0)
    v_cmp_gt_u32 vcc, 1, v164
    s_cbranch_vccz SD_62
    s_sleep 1
    s_sub_u32 s83, s83, 1
    s_cmp_lg_u32 s83, 0
    s_cbranch_scc1 SP_61
SD_62:
    s_waitcnt vmcnt(0)
    ds_write_b128 v5, v[104:107]
    ds_write_b128 v5, v[108:111] offset:1024
    s_mov_b64 exec, 1
    ds_write_b8 v161, v163 offset:44
    s_mov_b64 exec, -1
    s_waitcnt lgkmcnt(0)
    s_endpgm
K_PROD:
    s_memrealtime s[48:49]
    v_lshrrev_b32 v2, 3, v1
    v_and_b32 v3, 7, v1
    s_lshr_b32 s77, s2, 3
    s_bfe_u32 s76, s2, 0x20001
    s_lshl_b32 s69, s76, 3
    s_lshl_b32 s77, s77, 1
    s_add_u32 s69, s69, s77
    s_and_b32 s76, s2, 1
    s_add_u32 s69, s69, s76
    s_xor_b32 s76, s76, 1
    s_lshr_b32 s70, s2, 1
    s_min_u32 s70, s70, 13
    s_mul_i32 s76, s76, 14
    s_add_u32 s70, s70, s76
    s_lshl_b32 s76, s68, 3
    v_add_u32 v4, s76, v2
    s_lshl_b32 s77, s69, 6
    v_add_u32 v5, s77, v4
    v_mul_u32_u24 v6, 896, v5
    v_lshl_add_u32 v6, v3, 4, v6
    s_waitcnt lgkmcnt(0)
    s_mov_b32 s40, s16
    s_and_b32 s41, s17, 0xffff
    s_mov_b32 s42, 0x1c0000
    s_mov_b32 s43, 0x00020000
    buffer_load_dwordx4 v[32:35], v6, s[40:43], 0 offen offset:0
    buffer_load_dwordx4 v[36:39], v6, s[40:43], 0 offen offset:128
    buffer_load_dwordx4 v[40:43], v6, s[40:43], 0 offen offset:256
    buffer_load_dwordx4 v[44:47], v6, s[40:43], 0 offen offset:384
    buffer_load_dwordx4 v[48:51], v6, s[40:43], 0 offen offset:512
    buffer_load_dwordx4 v[52:55], v6, s[40:43], 0 offen offset:640
    buffer_load_dwordx4 v[56:59], v6, s[40:43], 0 offen offset:768
    s_add_u32 s52, s14, 0x7000000
    s_addc_u32 s53, s15, 0
    s_and_b32 s53, s53, 0xffff
    s_and_b32 s52, s52, 0xfe000000
    s_mov_b32 s54, 0x2000000
    s_mov_b32 s55, 0x00020000
    s_mov_b32 s64, s12
    s_and_b32 s65, s13, 0xffff
    s_mov_b32 s66, 0x100
    s_mov_b32 s67, 0x00020000
    s_or_b32 s76, s2, s68
    s_cbranch_scc1 NN_63
    s_memrealtime s[84:85]
    s_waitcnt lgkmcnt(0)
    s_or_b32 s85, s85, 0x40000000
    s_or_b32 s84, s84, 1
    v_mov_b32 v12, s84
    v_mov_b32 v13, s85
    v_mov_b32 v14, 64
    s_mov_b64 exec, 1
    buffer_store_dwordx2 v[12:13], v14, s[64:67], 0 offen sc1
    s_mov_b64 exec, -1
NN_63:
    s_lshr_b32 s77, s68, 1
    s_mul_i32 s77, s77, 401408
    s_lshl_b32 s78, s70, 7
    s_add_u32 s77, s77, s78
    v_mul_u32_u24 v9, 3584, v2
    v_lshl_add_u32 v9, v3, 4, v9
    v_add_u32 v9, s77, v9
    s_bitcmp0_b32 s68, 0
    s_cselect_b32 s44, s32, s34
    s_cselect_b32 s45, s33, s35
    s_and_b32 s45, s45, 0xffff
    s_mov_b32 s46, 0x188000
    s_mov_b32 s47, 0x00020000
    s_mov_b32 s38, 0x3f803f80
    v_mov_b32 v10, 0
    v_mov_b32 v11, 0
    v_mov_b32 v12, 0
    v_mov_b32 v13, 0
    v_mul_u32_u24 v7, 912, v4
    v_lshl_add_u32 v7, v3, 4, v7
    v_lshlrev_b32 v8, 4, v5
    s_lshl_b32 s78, s2, 8
    s_add_u32 s78, s78, 7733248
    v_lshl_add_u32 v28, v1, 13, s78
    s_lshl_b32 s76, s69, 8
    s_add_u32 s76, s76, 7864320
    s_lshl_b32 s77, s70, 8
    s_add_u32 s77, s77, 7872512
    s_cmp_eq_u32 s68, 0
    s_cselect_b32 s76, s76, s77
    v_mov_b32 v29, s76
    v_mov_b32 v30, 64
    v_mov_b32 v141, v28
    v_writelane_b32 v141, s76, 8
    s_cmp_lt_u32 s68, 2
    s_cselect_b32 exec_lo, 0x1ff, 0
    s_mov_b32 exec_hi, 0
    buffer_load_dword v141, v141, s[52:55], 0 offen sc1
    s_mov_b64 exec, -1
    s_waitcnt vmcnt(6)
    v_dot2_f32_bf16 v10, v32, s38, v10
    v_dot2_f32_bf16 v11, v32, v32, v11
    v_dot2_f32_bf16 v12, v33, s38, v12
    v_dot2_f32_bf16 v13, v33, v33, v13
    v_dot2_f32_bf16 v10, v34, s38, v10
    v_dot2_f32_bf16 v11, v34, v34, v11
    v_dot2_f32_bf16 v12, v35, s38, v12
    v_dot2_f32_bf16 v13, v35, v35, v13
    s_waitcnt vmcnt(5)
    v_dot2_f32_bf16 v10, v36, s38, v10
    v_dot2_f32_bf16 v11, v36, v36, v11
    v_dot2_f32_bf16 v12, v37, s38, v12
    v_dot2_f32_bf16 v13, v37, v37, v13
    v_dot2_f32_bf16 v10, v38, s38, v10
    v_dot2_f32_bf16 v11, v38, v38, v11
    v_dot2_f32_bf16 v12, v39, s38, v12
    v_dot2_f32_bf16 v13, v39, v39, v13
    s_waitcnt vmcnt(4)
    v_dot2_f32_bf16 v10, v40, s38, v10
    v_dot2_f32_bf16 v11, v40, v40, v11
    v_dot2_f32_bf16 v12, v41, s38, v12
    v_dot2_f32_bf16 v13, v41, v41, v13
    v_dot2_f32_bf16 v10, v42, s38, v10
    v_dot2_f32_bf16 v11, v42, v42, v11
    v_dot2_f32_bf16 v12, v43, s38, v12
    v_dot2_f32_bf16 v13, v43, v43, v13
    s_waitcnt vmcnt(3)
    v_dot2_f32_bf16 v10, v44, s38, v10
    v_dot2_f32_bf16 v11, v44, v44, v11
    v_dot2_f32_bf16 v12, v45, s38, v12
    v_dot2_f32_bf16 v13, v45, v45, v13
    v_dot2_f32_bf16 v10, v46, s38, v10
    v_dot2_f32_bf16 v11, v46, v46, v11
    v_dot2_f32_bf16 v12, v47, s38, v12
    v_dot2_f32_bf16 v13, v47, v47, v13
    s_waitcnt vmcnt(2)
    v_dot2_f32_bf16 v10, v48, s38, v10
    v_dot2_f32_bf16 v11, v48, v48, v11
    v_dot2_f32_bf16 v12, v49, s38, v12
    v_dot2_f32_bf16 v13, v49, v49, v13
    v_dot2_f32_bf16 v10, v50, s38, v10
    v_dot2_f32_bf16 v11, v50, v50, v11
    v_dot2_f32_bf16 v12, v51, s38, v12
    v_dot2_f32_bf16 v13, v51, v51, v13
    s_waitcnt vmcnt(1)
    v_dot2_f32_bf16 v10, v52, s38, v10
    v_dot2_f32_bf16 v11, v52, v52, v11
    v_dot2_f32_bf16 v12, v53, s38, v12
    v_dot2_f32_bf16 v13, v53, v53, v13
    v_dot2_f32_bf16 v10, v54, s38, v10
    v_dot2_f32_bf16 v11, v54, v54, v11
    v_dot2_f32_bf16 v12, v55, s38, v12
    v_dot2_f32_bf16 v13, v55, v55, v13
    s_waitcnt vmcnt(0)
    v_dot2_f32_bf16 v10, v56, s38, v10
    v_dot2_f32_bf16 v11, v56, v56, v11
    v_dot2_f32_bf16 v12, v57, s38, v12
    v_dot2_f32_bf16 v13, v57, v57, v13
    v_dot2_f32_bf16 v10, v58, s38, v10
    v_dot2_f32_bf16 v11, v58, v58, v11
    v_dot2_f32_bf16 v12, v59, s38, v12
    v_dot2_f32_bf16 v13, v59, v59, v13
    s_mov_b32 s81, 0
    buffer_load_dwordx4 v[64:67], v9, s[44:47], s81 offen
    s_mov_b32 s81, 28672
    buffer_load_dwordx4 v[68:71], v9, s[44:47], s81 offen
    s_mov_b32 s81, 57344
    buffer_load_dwordx4 v[72:75], v9, s[44:47], s81 offen
    v_add_f32 v10, v10, v12
    v_add_f32 v11, v11, v13
    s_nop 0
    v_add_f32_dpp v10, v10, v10 quad_perm:[1,0,3,2] row_mask:0xf bank_mask:0xf
    v_add_f32_dpp v11, v11, v11 quad_perm:[1,0,3,2] row_mask:0xf bank_mask:0xf
    s_nop 0
    v_add_f32_dpp v10, v10, v10 quad_perm:[2,3,0,1] row_mask:0xf bank_mask:0xf
    v_add_f32_dpp v11, v11, v11 quad_perm:[2,3,0,1] row_mask:0xf bank_mask:0xf
    s_nop 0
    v_add_f32_dpp v10, v10, v10 row_half_mirror row_mask:0xf bank_mask:0xf
    v_add_f32_dpp v11, v11, v11 row_half_mirror row_mask:0xf bank_mask:0xf
    v_mul_f32 v10, 0x3b124925, v10
    v_mul_f32 v11, 0x3b124925, v11
    v_fma_f32 v11, -v10, v10, v11
    v_max_f32 v11, 0, v11
    v_cvt_pk_bf16_f32 v10, v10, v11
    v_lshlrev_b32 v12, 16, v10
    v_and_b32 v11, 0xffff0000, v10
    v_add_f32 v11, 0x3727c5ac, v11
    v_cvt_pk_bf16_f32 v11, v11, v11
    v_lshlrev_b32 v11, 16, v11
    v_sqrt_f32 v11, v11
    s_nop 0
    v_cvt_pk_bf16_f32 v11, v11, v11
    v_lshlrev_b32 v11, 16, v11
    v_rcp_f32 v14, v11
    v_sub_f32 v16, 0, v12
    v_cvt_pk_bf16_f32 v24, v16, v16
    v_mul_f32 v27, v11, v11
    v_mul_f32 v25, 0xc0135761, v14
    v_mul_f32 v10, v14, v14
    v_mul_f32 v10, v10, v14
    v_mul_f32 v26, 0xbdd2d3e8, v10
    s_mov_b32 s76, 7880704
    s_mov_b32 exec_lo, 0x01010101
    s_mov_b32 exec_hi, 0x01010101
    buffer_store_dwordx4 v[24:27], v8, s[52:55], s76 offen sc1
    s_cmp_lt_u32 s68, 2
    s_cselect_b32 exec_lo, 1, 0
    s_mov_b32 exec_hi, 0
    buffer_load_dwordx2 v[18:19], v30, s[64:67], 0 offen sc1
    s_mov_b64 exec, -1
    v_lshlrev_b32 v20, 16, v32
    v_and_b32 v21, 0xffff0000, v32
    v_pk_add_f32 v[20:21], v[20:21], v[16:17] op_sel_hi:[1,0]
    v_cvt_pk_bf16_f32 v20, v20, v21
    v_and_b32 v21, 0xffff0000, v20
    v_lshlrev_b32 v20, 16, v20
    v_pk_mul_f32 v[20:21], v[20:21], v[14:15] op_sel_hi:[1,0]
    v_cvt_pk_bf16_f32 v20, v20, v21
    v_and_b32 v21, 0xffff0000, v20
    v_lshlrev_b32 v20, 16, v20
    v_cvt_pk_f16_f32 v32, v20, v21
    v_lshlrev_b32 v22, 16, v33
    v_and_b32 v23, 0xffff0000, v33
    v_pk_add_f32 v[22:23], v[22:23], v[16:17] op_sel_hi:[1,0]
    v_cvt_pk_bf16_f32 v22, v22, v23
    v_and_b32 v23, 0xffff0000, v22
    v_lshlrev_b32 v22, 16, v22
    v_pk_mul_f32 v[22:23], v[22:23], v[14:15] op_sel_hi:[1,0]
    v_cvt_pk_bf16_f32 v22, v22, v23
    v_and_b32 v23, 0xffff0000, v22
    v_lshlrev_b32 v22, 16, v22
    v_cvt_pk_f16_f32 v33, v22, v23
    v_lshlrev_b32 v20, 16, v34
    v_and_b32 v21, 0xffff0000, v34
    v_pk_add_f32 v[20:21], v[20:21], v[16:17] op_sel_hi:[1,0]
    v_cvt_pk_bf16_f32 v20, v20, v21
    v_and_b32 v21, 0xffff0000, v20
    v_lshlrev_b32 v20, 16, v20
    v_pk_mul_f32 v[20:21], v[20:21], v[14:15] op_sel_hi:[1,0]
    v_cvt_pk_bf16_f32 v20, v20, v21
    v_and_b32 v21, 0xffff0000, v20
    v_lshlrev_b32 v20, 16, v20
    v_cvt_pk_f16_f32 v34, v20, v21
    v_lshlrev_b32 v22, 16, v35
    v_and_b32 v23, 0xffff0000, v35
    v_pk_add_f32 v[22:23], v[22:23], v[16:17] op_sel_hi:[1,0]
    v_cvt_pk_bf16_f32 v22, v22, v23
    v_and_b32 v23, 0xffff0000, v22
    v_lshlrev_b32 v22, 16, v22
    v_pk_mul_f32 v[22:23], v[22:23], v[14:15] op_sel_hi:[1,0]
    v_cvt_pk_bf16_f32 v22, v22, v23
    v_and_b32 v23, 0xffff0000, v22
    v_lshlrev_b32 v22, 16, v22
    v_cvt_pk_f16_f32 v35, v22, v23
    ds_write_b128 v7, v[32:35] offset:0
    s_mov_b32 s81, 86016
    buffer_load_dwordx4 v[76:79], v9, s[44:47], s81 offen
    s_mov_b32 s81, 114688
    buffer_load_dwordx4 v[80:83], v9, s[44:47], s81 offen
    v_lshlrev_b32 v20, 16, v36
    v_and_b32 v21, 0xffff0000, v36
    v_pk_add_f32 v[20:21], v[20:21], v[16:17] op_sel_hi:[1,0]
    v_cvt_pk_bf16_f32 v20, v20, v21
    v_and_b32 v21, 0xffff0000, v20
    v_lshlrev_b32 v20, 16, v20
    v_pk_mul_f32 v[20:21], v[20:21], v[14:15] op_sel_hi:[1,0]
    v_cvt_pk_bf16_f32 v20, v20, v21
    v_and_b32 v21, 0xffff0000, v20
    v_lshlrev_b32 v20, 16, v20
    v_cvt_pk_f16_f32 v36, v20, v21
    v_lshlrev_b32 v22, 16, v37
    v_and_b32 v23, 0xffff0000, v37
    v_pk_add_f32 v[22:23], v[22:23], v[16:17] op_sel_hi:[1,0]
    v_cvt_pk_bf16_f32 v22, v22, v23
    v_and_b32 v23, 0xffff0000, v22
    v_lshlrev_b32 v22, 16, v22
    v_pk_mul_f32 v[22:23], v[22:23], v[14:15] op_sel_hi:[1,0]
    v_cvt_pk_bf16_f32 v22, v22, v23
    v_and_b32 v23, 0xffff0000, v22
    v_lshlrev_b32 v22, 16, v22
    v_cvt_pk_f16_f32 v37, v22, v23
    v_lshlrev_b32 v20, 16, v38
    v_and_b32 v21, 0xffff0000, v38
    v_pk_add_f32 v[20:21], v[20:21], v[16:17] op_sel_hi:[1,0]
    v_cvt_pk_bf16_f32 v20, v20, v21
    v_and_b32 v21, 0xffff0000, v20
    v_lshlrev_b32 v20, 16, v20
    v_pk_mul_f32 v[20:21], v[20:21], v[14:15] op_sel_hi:[1,0]
    v_cvt_pk_bf16_f32 v20, v20, v21
    v_and_b32 v21, 0xffff0000, v20
    v_lshlrev_b32 v20, 16, v20
    v_cvt_pk_f16_f32 v38, v20, v21
    v_lshlrev_b32 v22, 16, v39
    v_and_b32 v23, 0xffff0000, v39
    v_pk_add_f32 v[22:23], v[22:23], v[16:17] op_sel_hi:[1,0]
    v_cvt_pk_bf16_f32 v22, v22, v23
    v_and_b32 v23, 0xffff0000, v22
    v_lshlrev_b32 v22, 16, v22
    v_pk_mul_f32 v[22:23], v[22:23], v[14:15] op_sel_hi:[1,0]
    v_cvt_pk_bf16_f32 v22, v22, v23
    v_and_b32 v23, 0xffff0000, v22
    v_lshlrev_b32 v22, 16, v22
    v_cvt_pk_f16_f32 v39, v22, v23
    ds_write_b128 v7, v[36:39] offset:128
    s_mov_b32 s81, 143360
    buffer_load_dwordx4 v[84:87], v9, s[44:47], s81 offen
    s_mov_b32 s81, 172032
    buffer_load_dwordx4 v[88:91], v9, s[44:47], s81 offen
    v_lshlrev_b32 v20, 16, v40
    v_and_b32 v21, 0xffff0000, v40
    v_pk_add_f32 v[20:21], v[20:21], v[16:17] op_sel_hi:[1,0]
    v_cvt_pk_bf16_f32 v20, v20, v21
    v_and_b32 v21, 0xffff0000, v20
    v_lshlrev_b32 v20, 16, v20
    v_pk_mul_f32 v[20:21], v[20:21], v[14:15] op_sel_hi:[1,0]
    v_cvt_pk_bf16_f32 v20, v20, v21
    v_and_b32 v21, 0xffff0000, v20
    v_lshlrev_b32 v20, 16, v20
    v_cvt_pk_f16_f32 v40, v20, v21
    v_lshlrev_b32 v22, 16, v41
    v_and_b32 v23, 0xffff0000, v41
    v_pk_add_f32 v[22:23], v[22:23], v[16:17] op_sel_hi:[1,0]
    v_cvt_pk_bf16_f32 v22, v22, v23
    v_and_b32 v23, 0xffff0000, v22
    v_lshlrev_b32 v22, 16, v22
    v_pk_mul_f32 v[22:23], v[22:23], v[14:15] op_sel_hi:[1,0]
    v_cvt_pk_bf16_f32 v22, v22, v23
    v_and_b32 v23, 0xffff0000, v22
    v_lshlrev_b32 v22, 16, v22
    v_cvt_pk_f16_f32 v41, v22, v23
    v_lshlrev_b32 v20, 16, v42
    v_and_b32 v21, 0xffff0000, v42
    v_pk_add_f32 v[20:21], v[20:21], v[16:17] op_sel_hi:[1,0]
    v_cvt_pk_bf16_f32 v20, v20, v21
    v_and_b32 v21, 0xffff0000, v20
    v_lshlrev_b32 v20, 16, v20
    v_pk_mul_f32 v[20:21], v[20:21], v[14:15] op_sel_hi:[1,0]
    v_cvt_pk_bf16_f32 v20, v20, v21
    v_and_b32 v21, 0xffff0000, v20
    v_lshlrev_b32 v20, 16, v20
    v_cvt_pk_f16_f32 v42, v20, v21
    v_lshlrev_b32 v22, 16, v43
    v_and_b32 v23, 0xffff0000, v43
    v_pk_add_f32 v[22:23], v[22:23], v[16:17] op_sel_hi:[1,0]
    v_cvt_pk_bf16_f32 v22, v22, v23
    v_and_b32 v23, 0xffff0000, v22
    v_lshlrev_b32 v22, 16, v22
    v_pk_mul_f32 v[22:23], v[22:23], v[14:15] op_sel_hi:[1,0]
    v_cvt_pk_bf16_f32 v22, v22, v23
    v_and_b32 v23, 0xffff0000, v22
    v_lshlrev_b32 v22, 16, v22
    v_cvt_pk_f16_f32 v43, v22, v23
    ds_write_b128 v7, v[40:43] offset:256
    s_mov_b32 s81, 200704
    buffer_load_dwordx4 v[92:95], v9, s[44:47], s81 offen
    s_mov_b32 s81, 229376
    buffer_load_dwordx4 v[96:99], v9, s[44:47], s81 offen
    v_lshlrev_b32 v20, 16, v44
    v_and_b32 v21, 0xffff0000, v44
    v_pk_add_f32 v[20:21], v[20:21], v[16:17] op_sel_hi:[1,0]
    v_cvt_pk_bf16_f32 v20, v20, v21
    v_and_b32 v21, 0xffff0000, v20
    v_lshlrev_b32 v20, 16, v20
    v_pk_mul_f32 v[20:21], v[20:21], v[14:15] op_sel_hi:[1,0]
    v_cvt_pk_bf16_f32 v20, v20, v21
    v_and_b32 v21, 0xffff0000, v20
    v_lshlrev_b32 v20, 16, v20
    v_cvt_pk_f16_f32 v44, v20, v21
    v_lshlrev_b32 v22, 16, v45
    v_and_b32 v23, 0xffff0000, v45
    v_pk_add_f32 v[22:23], v[22:23], v[16:17] op_sel_hi:[1,0]
    v_cvt_pk_bf16_f32 v22, v22, v23
    v_and_b32 v23, 0xffff0000, v22
    v_lshlrev_b32 v22, 16, v22
    v_pk_mul_f32 v[22:23], v[22:23], v[14:15] op_sel_hi:[1,0]
    v_cvt_pk_bf16_f32 v22, v22, v23
    v_and_b32 v23, 0xffff0000, v22
    v_lshlrev_b32 v22, 16, v22
    v_cvt_pk_f16_f32 v45, v22, v23
    v_lshlrev_b32 v20, 16, v46
    v_and_b32 v21, 0xffff0000, v46
    v_pk_add_f32 v[20:21], v[20:21], v[16:17] op_sel_hi:[1,0]
    v_cvt_pk_bf16_f32 v20, v20, v21
    v_and_b32 v21, 0xffff0000, v20
    v_lshlrev_b32 v20, 16, v20
    v_pk_mul_f32 v[20:21], v[20:21], v[14:15] op_sel_hi:[1,0]
    v_cvt_pk_bf16_f32 v20, v20, v21
    v_and_b32 v21, 0xffff0000, v20
    v_lshlrev_b32 v20, 16, v20
    v_cvt_pk_f16_f32 v46, v20, v21
    v_lshlrev_b32 v22, 16, v47
    v_and_b32 v23, 0xffff0000, v47
    v_pk_add_f32 v[22:23], v[22:23], v[16:17] op_sel_hi:[1,0]
    v_cvt_pk_bf16_f32 v22, v22, v23
    v_and_b32 v23, 0xffff0000, v22
    v_lshlrev_b32 v22, 16, v22
    v_pk_mul_f32 v[22:23], v[22:23], v[14:15] op_sel_hi:[1,0]
    v_cvt_pk_bf16_f32 v22, v22, v23
    v_and_b32 v23, 0xffff0000, v22
    v_lshlrev_b32 v22, 16, v22
    v_cvt_pk_f16_f32 v47, v22, v23
    ds_write_b128 v7, v[44:47] offset:384
    s_mov_b32 s81, 258048
    buffer_load_dwordx4 v[100:103], v9, s[44:47], s81 offen
    s_mov_b32 s81, 286720
    buffer_load_dwordx4 v[104:107], v9, s[44:47], s81 offen
    v_lshlrev_b32 v20, 16, v48
    v_and_b32 v21, 0xffff0000, v48
    v_pk_add_f32 v[20:21], v[20:21], v[16:17] op_sel_hi:[1,0]
    v_cvt_pk_bf16_f32 v20, v20, v21
    v_and_b32 v21, 0xffff0000, v20
    v_lshlrev_b32 v20, 16, v20
    v_pk_mul_f32 v[20:21], v[20:21], v[14:15] op_sel_hi:[1,0]
    v_cvt_pk_bf16_f32 v20, v20, v21
    v_and_b32 v21, 0xffff0000, v20
    v_lshlrev_b32 v20, 16, v20
    v_cvt_pk_f16_f32 v48, v20, v21
    v_lshlrev_b32 v22, 16, v49
    v_and_b32 v23, 0xffff0000, v49
    v_pk_add_f32 v[22:23], v[22:23], v[16:17] op_sel_hi:[1,0]
    v_cvt_pk_bf16_f32 v22, v22, v23
    v_and_b32 v23, 0xffff0000, v22
    v_lshlrev_b32 v22, 16, v22
    v_pk_mul_f32 v[22:23], v[22:23], v[14:15] op_sel_hi:[1,0]
    v_cvt_pk_bf16_f32 v22, v22, v23
    v_and_b32 v23, 0xffff0000, v22
    v_lshlrev_b32 v22, 16, v22
    v_cvt_pk_f16_f32 v49, v22, v23
    v_lshlrev_b32 v20, 16, v50
    v_and_b32 v21, 0xffff0000, v50
    v_pk_add_f32 v[20:21], v[20:21], v[16:17] op_sel_hi:[1,0]
    v_cvt_pk_bf16_f32 v20, v20, v21
    v_and_b32 v21, 0xffff0000, v20
    v_lshlrev_b32 v20, 16, v20
    v_pk_mul_f32 v[20:21], v[20:21], v[14:15] op_sel_hi:[1,0]
    v_cvt_pk_bf16_f32 v20, v20, v21
    v_and_b32 v21, 0xffff0000, v20
    v_lshlrev_b32 v20, 16, v20
    v_cvt_pk_f16_f32 v50, v20, v21
    v_lshlrev_b32 v22, 16, v51
    v_and_b32 v23, 0xffff0000, v51
    v_pk_add_f32 v[22:23], v[22:23], v[16:17] op_sel_hi:[1,0]
    v_cvt_pk_bf16_f32 v22, v22, v23
    v_and_b32 v23, 0xffff0000, v22
    v_lshlrev_b32 v22, 16, v22
    v_pk_mul_f32 v[22:23], v[22:23], v[14:15] op_sel_hi:[1,0]
    v_cvt_pk_bf16_f32 v22, v22, v23
    v_and_b32 v23, 0xffff0000, v22
    v_lshlrev_b32 v22, 16, v22
    v_cvt_pk_f16_f32 v51, v22, v23
    ds_write_b128 v7, v[48:51] offset:512
    s_mov_b32 s81, 315392
    buffer_load_dwordx4 v[108:111], v9, s[44:47], s81 offen
    s_mov_b32 s81, 344064
    buffer_load_dwordx4 v[112:115], v9, s[44:47], s81 offen
    v_lshlrev_b32 v20, 16, v52
    v_and_b32 v21, 0xffff0000, v52
    v_pk_add_f32 v[20:21], v[20:21], v[16:17] op_sel_hi:[1,0]
    v_cvt_pk_bf16_f32 v20, v20, v21
    v_and_b32 v21, 0xffff0000, v20
    v_lshlrev_b32 v20, 16, v20
    v_pk_mul_f32 v[20:21], v[20:21], v[14:15] op_sel_hi:[1,0]
    v_cvt_pk_bf16_f32 v20, v20, v21
    v_and_b32 v21, 0xffff0000, v20
    v_lshlrev_b32 v20, 16, v20
    v_cvt_pk_f16_f32 v52, v20, v21
    v_lshlrev_b32 v22, 16, v53
    v_and_b32 v23, 0xffff0000, v53
    v_pk_add_f32 v[22:23], v[22:23], v[16:17] op_sel_hi:[1,0]
    v_cvt_pk_bf16_f32 v22, v22, v23
    v_and_b32 v23, 0xffff0000, v22
    v_lshlrev_b32 v22, 16, v22
    v_pk_mul_f32 v[22:23], v[22:23], v[14:15] op_sel_hi:[1,0]
    v_cvt_pk_bf16_f32 v22, v22, v23
    v_and_b32 v23, 0xffff0000, v22
    v_lshlrev_b32 v22, 16, v22
    v_cvt_pk_f16_f32 v53, v22, v23
    v_lshlrev_b32 v20, 16, v54
    v_and_b32 v21, 0xffff0000, v54
    v_pk_add_f32 v[20:21], v[20:21], v[16:17] op_sel_hi:[1,0]
    v_cvt_pk_bf16_f32 v20, v20, v21
    v_and_b32 v21, 0xffff0000, v20
    v_lshlrev_b32 v20, 16, v20
    v_pk_mul_f32 v[20:21], v[20:21], v[14:15] op_sel_hi:[1,0]
    v_cvt_pk_bf16_f32 v20, v20, v21
    v_and_b32 v21, 0xffff0000, v20
    v_lshlrev_b32 v20, 16, v20
    v_cvt_pk_f16_f32 v54, v20, v21
    v_lshlrev_b32 v22, 16, v55
    v_and_b32 v23, 0xffff0000, v55
    v_pk_add_f32 v[22:23], v[22:23], v[16:17] op_sel_hi:[1,0]
    v_cvt_pk_bf16_f32 v22, v22, v23
    v_and_b32 v23, 0xffff0000, v22
    v_lshlrev_b32 v22, 16, v22
    v_pk_mul_f32 v[22:23], v[22:23], v[14:15] op_sel_hi:[1,0]
    v_cvt_pk_bf16_f32 v22, v22, v23
    v_and_b32 v23, 0xffff0000, v22
    v_lshlrev_b32 v22, 16, v22
    v_cvt_pk_f16_f32 v55, v22, v23
    ds_write_b128 v7, v[52:55] offset:640
    s_mov_b32 s81, 372736
    buffer_load_dwordx4 v[116:119], v9, s[44:47], s81 offen
    v_lshlrev_b32 v20, 16, v56
    v_and_b32 v21, 0xffff0000, v56
    v_pk_add_f32 v[20:21], v[20:21], v[16:17] op_sel_hi:[1,0]
    v_cvt_pk_bf16_f32 v20, v20, v21
    v_and_b32 v21, 0xffff0000, v20
    v_lshlrev_b32 v20, 16, v20
    v_pk_mul_f32 v[20:21], v[20:21], v[14:15] op_sel_hi:[1,0]
    v_cvt_pk_bf16_f32 v20, v20, v21
    v_and_b32 v21, 0xffff0000, v20
    v_lshlrev_b32 v20, 16, v20
    v_cvt_pk_f16_f32 v56, v20, v21
    v_lshlrev_b32 v22, 16, v57
    v_and_b32 v23, 0xffff0000, v57
    v_pk_add_f32 v[22:23], v[22:23], v[16:17] op_sel_hi:[1,0]
    v_cvt_pk_bf16_f32 v22, v22, v23
    v_and_b32 v23, 0xffff0000, v22
    v_lshlrev_b32 v22, 16, v22
    v_pk_mul_f32 v[22:23], v[22:23], v[14:15] op_sel_hi:[1,0]
    v_cvt_pk_bf16_f32 v22, v22, v23
    v_and_b32 v23, 0xffff0000, v22
    v_lshlrev_b32 v22, 16, v22
    v_cvt_pk_f16_f32 v57, v22, v23
    v_lshlrev_b32 v20, 16, v58
    v_and_b32 v21, 0xffff0000, v58
    v_pk_add_f32 v[20:21], v[20:21], v[16:17] op_sel_hi:[1,0]
    v_cvt_pk_bf16_f32 v20, v20, v21
    v_and_b32 v21, 0xffff0000, v20
    v_lshlrev_b32 v20, 16, v20
    v_pk_mul_f32 v[20:21], v[20:21], v[14:15] op_sel_hi:[1,0]
    v_cvt_pk_bf16_f32 v20, v20, v21
    v_and_b32 v21, 0xffff0000, v20
    v_lshlrev_b32 v20, 16, v20
    v_cvt_pk_f16_f32 v58, v20, v21
    v_lshlrev_b32 v22, 16, v59
    v_and_b32 v23, 0xffff0000, v59
    v_pk_add_f32 v[22:23], v[22:23], v[16:17] op_sel_hi:[1,0]
    v_cvt_pk_bf16_f32 v22, v22, v23
    v_and_b32 v23, 0xffff0000, v22
    v_lshlrev_b32 v22, 16, v22
    v_pk_mul_f32 v[22:23], v[22:23], v[14:15] op_sel_hi:[1,0]
    v_cvt_pk_bf16_f32 v22, v22, v23
    v_and_b32 v23, 0xffff0000, v22
    v_lshlrev_b32 v22, 16, v22
    v_cvt_pk_f16_f32 v59, v22, v23
    ds_write_b128 v7, v[56:59] offset:768
    s_mov_b32 s80, 0x3f80
    s_mov_b32 s81, 0x3f800000
    v_mov_b32 v120, 0
    v_mov_b32 v121, 0
    v_mov_b32 v122, 0
    v_mov_b32 v123, 0
    v_mov_b32 v124, 0
    v_mov_b32 v125, 0
    v_mov_b32 v126, 0
    v_mov_b32 v127, 0
    s_waitcnt vmcnt(14)
    v_dot2_f32_bf16 v120, v64, s80, v120
    v_dot2_f32_bf16 v121, v64, s81, v121
    v_dot2_f32_bf16 v122, v65, s80, v122
    v_dot2_f32_bf16 v123, v65, s81, v123
    v_dot2_f32_bf16 v124, v66, s80, v124
    v_dot2_f32_bf16 v125, v66, s81, v125
    v_dot2_f32_bf16 v126, v67, s80, v126
    v_dot2_f32_bf16 v127, v67, s81, v127
    s_waitcnt vmcnt(13)
    v_dot2_f32_bf16 v120, v68, s80, v120
    v_dot2_f32_bf16 v121, v68, s81, v121
    v_dot2_f32_bf16 v122, v69, s80, v122
    v_dot2_f32_bf16 v123, v69, s81, v123
    v_dot2_f32_bf16 v124, v70, s80, v124
    v_dot2_f32_bf16 v125, v70, s81, v125
    v_dot2_f32_bf16 v126, v71, s80, v126
    v_dot2_f32_bf16 v127, v71, s81, v127
    s_waitcnt vmcnt(12)
    v_dot2_f32_bf16 v120, v72, s80, v120
    v_dot2_f32_bf16 v121, v72, s81, v121
    v_dot2_f32_bf16 v122, v73, s80, v122
    v_dot2_f32_bf16 v123, v73, s81, v123
    v_dot2_f32_bf16 v124, v74, s80, v124
    v_dot2_f32_bf16 v125, v74, s81, v125
    v_dot2_f32_bf16 v126, v75, s80, v126
    v_dot2_f32_bf16 v127, v75, s81, v127
    s_waitcnt vmcnt(10)
    v_dot2_f32_bf16 v120, v76, s80, v120
    v_dot2_f32_bf16 v121, v76, s81, v121
    v_dot2_f32_bf16 v122, v77, s80, v122
    v_dot2_f32_bf16 v123, v77, s81, v123
    v_dot2_f32_bf16 v124, v78, s80, v124
    v_dot2_f32_bf16 v125, v78, s81, v125
    v_dot2_f32_bf16 v126, v79, s80, v126
    v_dot2_f32_bf16 v127, v79, s81, v127
    s_waitcnt vmcnt(9)
    v_dot2_f32_bf16 v120, v80, s80, v120
    v_dot2_f32_bf16 v121, v80, s81, v121
    v_dot2_f32_bf16 v122, v81, s80, v122
    v_dot2_f32_bf16 v123, v81, s81, v123
    v_dot2_f32_bf16 v124, v82, s80, v124
    v_dot2_f32_bf16 v125, v82, s81, v125
    v_dot2_f32_bf16 v126, v83, s80, v126
    v_dot2_f32_bf16 v127, v83, s81, v127
    s_waitcnt vmcnt(8)
    v_dot2_f32_bf16 v120, v84, s80, v120
    v_dot2_f32_bf16 v121, v84, s81, v121
    v_dot2_f32_bf16 v122, v85, s80, v122
    v_dot2_f32_bf16 v123, v85, s81, v123
    v_dot2_f32_bf16 v124, v86, s80, v124
    v_dot2_f32_bf16 v125, v86, s81, v125
    v_dot2_f32_bf16 v126, v87, s80, v126
    v_dot2_f32_bf16 v127, v87, s81, v127
    s_waitcnt vmcnt(7)
    v_dot2_f32_bf16 v120, v88, s80, v120
    v_dot2_f32_bf16 v121, v88, s81, v121
    v_dot2_f32_bf16 v122, v89, s80, v122
    v_dot2_f32_bf16 v123, v89, s81, v123
    v_dot2_f32_bf16 v124, v90, s80, v124
    v_dot2_f32_bf16 v125, v90, s81, v125
    v_dot2_f32_bf16 v126, v91, s80, v126
    v_dot2_f32_bf16 v127, v91, s81, v127
    s_waitcnt vmcnt(6)
    v_dot2_f32_bf16 v120, v92, s80, v120
    v_dot2_f32_bf16 v121, v92, s81, v121
    v_dot2_f32_bf16 v122, v93, s80, v122
    v_dot2_f32_bf16 v123, v93, s81, v123
    v_dot2_f32_bf16 v124, v94, s80, v124
    v_dot2_f32_bf16 v125, v94, s81, v125
    v_dot2_f32_bf16 v126, v95, s80, v126
    v_dot2_f32_bf16 v127, v95, s81, v127
    s_waitcnt vmcnt(5)
    v_dot2_f32_bf16 v120, v96, s80, v120
    v_dot2_f32_bf16 v121, v96, s81, v121
    v_dot2_f32_bf16 v122, v97, s80, v122
    v_dot2_f32_bf16 v123, v97, s81, v123
    v_dot2_f32_bf16 v124, v98, s80, v124
    v_dot2_f32_bf16 v125, v98, s81, v125
    v_dot2_f32_bf16 v126, v99, s80, v126
    v_dot2_f32_bf16 v127, v99, s81, v127
    s_waitcnt vmcnt(4)
    v_dot2_f32_bf16 v120, v100, s80, v120
    v_dot2_f32_bf16 v121, v100, s81, v121
    v_dot2_f32_bf16 v122, v101, s80, v122
    v_dot2_f32_bf16 v123, v101, s81, v123
    v_dot2_f32_bf16 v124, v102, s80, v124
    v_dot2_f32_bf16 v125, v102, s81, v125
    v_dot2_f32_bf16 v126, v103, s80, v126
    v_dot2_f32_bf16 v127, v103, s81, v127
    s_waitcnt vmcnt(3)
    v_dot2_f32_bf16 v120, v104, s80, v120
    v_dot2_f32_bf16 v121, v104, s81, v121
    v_dot2_f32_bf16 v122, v105, s80, v122
    v_dot2_f32_bf16 v123, v105, s81, v123
    v_dot2_f32_bf16 v124, v106, s80, v124
    v_dot2_f32_bf16 v125, v106, s81, v125
    v_dot2_f32_bf16 v126, v107, s80, v126
    v_dot2_f32_bf16 v127, v107, s81, v127
    s_waitcnt vmcnt(2)
    v_dot2_f32_bf16 v120, v108, s80, v120
    v_dot2_f32_bf16 v121, v108, s81, v121
    v_dot2_f32_bf16 v122, v109, s80, v122
    v_dot2_f32_bf16 v123, v109, s81, v123
    v_dot2_f32_bf16 v124, v110, s80, v124
    v_dot2_f32_bf16 v125, v110, s81, v125
    v_dot2_f32_bf16 v126, v111, s80, v126
    v_dot2_f32_bf16 v127, v111, s81, v127
    s_waitcnt vmcnt(1)
    v_dot2_f32_bf16 v120, v112, s80, v120
    v_dot2_f32_bf16 v121, v112, s81, v121
    v_dot2_f32_bf16 v122, v113, s80, v122
    v_dot2_f32_bf16 v123, v113, s81, v123
    v_dot2_f32_bf16 v124, v114, s80, v124
    v_dot2_f32_bf16 v125, v114, s81, v125
    v_dot2_f32_bf16 v126, v115, s80, v126
    v_dot2_f32_bf16 v127, v115, s81, v127
    s_waitcnt vmcnt(0)
    v_dot2_f32_bf16 v120, v116, s80, v120
    v_dot2_f32_bf16 v121, v116, s81, v121
    v_dot2_f32_bf16 v122, v117, s80, v122
    v_dot2_f32_bf16 v123, v117, s81, v123
    v_dot2_f32_bf16 v124, v118, s80, v124
    v_dot2_f32_bf16 v125, v118, s81, v125
    v_dot2_f32_bf16 v126, v119, s80, v126
    v_dot2_f32_bf16 v127, v119, s81, v127
    v_add_f32_dpp v120, v120, v120 row_ror:8 row_mask:0xf bank_mask:0xf
    v_add_f32_dpp v121, v121, v121 row_ror:8 row_mask:0xf bank_mask:0xf
    v_add_f32_dpp v122, v122, v122 row_ror:8 row_mask:0xf bank_mask:0xf
    v_add_f32_dpp v123, v123, v123 row_ror:8 row_mask:0xf bank_mask:0xf
    v_add_f32_dpp v124, v124, v124 row_ror:8 row_mask:0xf bank_mask:0xf
    v_add_f32_dpp v125, v125, v125 row_ror:8 row_mask:0xf bank_mask:0xf
    v_add_f32_dpp v126, v126, v126 row_ror:8 row_mask:0xf bank_mask:0xf
    v_add_f32_dpp v127, v127, v127 row_ror:8 row_mask:0xf bank_mask:0xf
    v_mov_b32 v128, v120
    v_mov_b32 v129, v121
    v_mov_b32 v130, v122
    v_mov_b32 v131, v123
    v_mov_b32 v132, v124
    v_mov_b32 v133, v125
    v_mov_b32 v134, v126
    v_mov_b32 v135, v127
    v_permlane16_swap_b32 v120, v128
    v_permlane16_swap_b32 v121, v129
    v_permlane16_swap_b32 v122, v130
    v_permlane16_swap_b32 v123, v131
    v_permlane16_swap_b32 v124, v132
    v_permlane16_swap_b32 v125, v133
    v_permlane16_swap_b32 v126, v134
    v_permlane16_swap_b32 v127, v135
    v_add_f32 v120, v120, v128
    v_add_f32 v121, v121, v129
    v_add_f32 v122, v122, v130
    v_add_f32 v123, v123, v131
    v_add_f32 v124, v124, v132
    v_add_f32 v125, v125, v133
    v_add_f32 v126, v126, v134
    v_add_f32 v127, v127, v135
    v_mov_b32 v128, v120
    v_mov_b32 v129, v121
    v_mov_b32 v130, v122
    v_mov_b32 v131, v123
    v_mov_b32 v132, v124
    v_mov_b32 v133, v125
    v_mov_b32 v134, v126
    v_mov_b32 v135, v127
    v_permlane32_swap_b32 v120, v128
    v_permlane32_swap_b32 v121, v129
    v_permlane32_swap_b32 v122, v130
    v_permlane32_swap_b32 v123, v131
    v_permlane32_swap_b32 v124, v132
    v_permlane32_swap_b32 v125, v133
    v_permlane32_swap_b32 v126, v134
    v_permlane32_swap_b32 v127, v135
    v_add_f32 v120, v120, v128
    v_add_f32 v121, v121, v129
    v_add_f32 v122, v122, v130
    v_add_f32 v123, v123, v131
    v_add_f32 v124, v124, v132
    v_add_f32 v125, v125, v133
    v_add_f32 v126, v126, v134
    v_add_f32 v127, v127, v135
    s_lshl_b32 s76, s68, 8
    s_add_u32 s76, s76, 58368
    v_lshl_add_u32 v9, v3, 5, s76
    s_mov_b64 exec, 0xff
    ds_write_b128 v9, v[120:123]
    ds_write_b128 v9, v[124:127] offset:16
    s_mov_b64 exec, -1
    v_lshrrev_b32 v4, 4, v1
    v_and_b32 v5, 15, v1
    v_lshrrev_b32 v6, 2, v5
    v_lshl_add_u32 v6, v4, 3, v6
    v_bfe_u32 v7, v5, 1, 1
    v_lshl_add_u32 v6, v7, 5, v6
    v_mul_u32_u24 v6, 912, v6
    v_and_b32 v7, 1, v5
    v_lshl_add_u32 v6, v7, 3, v6
    s_lshl_b32 s80, s68, 4
    v_add_u32 v6, s80, v6
    s_mul_i32 s80, s68, 8064
    s_add_u32 s80, s80, 60416
    v_and_b32 v31, 7, v5
    v_mul_u32_u24 v31, 144, v31
    v_lshl_add_u32 v31, v4, 4, v31
    v_lshrrev_b32 v5, 3, v5
    v_lshl_add_u32 v31, v5, 6, v31
    v_add_u32 v31, s80, v31
    v_mul_u32_u24 v8, 144, v2
    v_lshl_add_u32 v8, v3, 4, v8
    v_add_u32 v8, s80, v8
    v_mul_u32_u24 v7, 4096, v2
    v_lshl_add_u32 v7, v3, 4, v7
    s_lshl_b32 s78, s69, 7
    s_add_u32 s78, s78, 8388608
    s_mul_i32 s77, s68, 32768
    s_add_u32 s77, s77, s78
    s_cmp_gt_u32 s68, 1
    s_cbranch_scc1 PA_64
    s_mov_b32 s83, 32768
    s_mov_b32 s49, 2
    s_branch GN_67
GN_65:
    buffer_load_dwordx2 v[18:19], v30, s[64:67], 0 offen sc1
GN_67:
    s_waitcnt vmcnt(0)
    v_readfirstlane_b32 s84, v18
    v_readfirstlane_b32 s85, v19
    s_nop 0
    s_cmp_eq_u32 s85, 0
    s_cbranch_scc1 GN_68
    s_sub_u32 s76, s48, s84
    s_cmp_lt_i32 s76, 800
    s_cbranch_scc1 GN_66
    s_sub_u32 s49, s49, 1
    s_cbranch_scc1 GN_66
GN_68:
    s_sleep 8
    s_sub_u32 s83, s83, 1
    s_cmp_lg_u32 s83, 0
    s_cbranch_scc1 GN_65
GN_66:
    v_mov_b32 v10, s84
PA_64:
    s_waitcnt vmcnt(0) lgkmcnt(0)
    s_barrier
    s_cmp_lg_u32 s68, 1
    s_cbranch_scc1 PA_69
    v_lshlrev_b32 v9, 2, v1
    v_add_u32 v20, 58368, v9
    ds_read_b32 v120, v20 offset:0
    ds_read_b32 v121, v20 offset:256
    ds_read_b32 v122, v20 offset:512
    ds_read_b32 v123, v20 offset:768
    ds_read_b32 v124, v20 offset:1024
    ds_read_b32 v125, v20 offset:1280
    ds_read_b32 v126, v20 offset:1536
    ds_read_b32 v127, v20 offset:1792
    s_lshl_b32 s78, s70, 9
    s_add_u32 s76, s78, 7946240
    s_add_u32 s78, s76, 14336
    v_lshlrev_b32 v9, 3, v1
    s_waitcnt lgkmcnt(0)
    v_add_f32 v120, v120, v122
    v_add_f32 v124, v124, v126
    v_add_f32 v120, v120, v124
    v_cvt_pk_bf16_f32 v122, v120, v120
    v_lshlrev_b32 v122, 16, v122
    v_sub_f32 v122, v120, v122
    v_cvt_pk_bf16_f32 v128, v120, v122
    v_and_b32 v124, 0xffff0000, v128
    v_sub_f32 v122, v122, v124
    v_cvt_pk_bf16_f32 v129, v122, 0
    buffer_store_dwordx2 v[128:129], v9, s[52:55], s76 offen sc1
    v_add_f32 v121, v121, v123
    v_add_f32 v125, v125, v127
    v_add_f32 v121, v121, v125
    v_cvt_pk_bf16_f32 v123, v121, v121
    v_lshlrev_b32 v123, 16, v123
    v_sub_f32 v123, v121, v123
    v_cvt_pk_bf16_f32 v130, v121, v123
    v_and_b32 v125, 0xffff0000, v130
    v_sub_f32 v123, v123, v125
    v_cvt_pk_bf16_f32 v131, v123, 0
    buffer_store_dwordx2 v[130:131], v9, s[52:55], s78 offen sc1
PA_69:
    s_cmp_eq_u32 s68, 0
    s_cselect_b32 exec_lo, 1, 0
    s_mov_b32 exec_hi, 0
    buffer_store_dword v10, v29, s[52:55], 0 offen sc1
    s_mov_b64 exec, -1
    ds_read_b64_tr_b16 v[32:33], v6 offset:0
    ds_read_b64_tr_b16 v[34:35], v6 offset:3648
    ds_read_b64_tr_b16 v[36:37], v6 offset:128
    ds_read_b64_tr_b16 v[38:39], v6 offset:3776
    ds_read_b64_tr_b16 v[40:41], v6 offset:256
    ds_read_b64_tr_b16 v[42:43], v6 offset:3904
    ds_read_b64_tr_b16 v[44:45], v6 offset:384
    ds_read_b64_tr_b16 v[46:47], v6 offset:4032
    ds_read_b64_tr_b16 v[48:49], v6 offset:512
    ds_read_b64_tr_b16 v[50:51], v6 offset:4160
    ds_read_b64_tr_b16 v[52:53], v6 offset:640
    ds_read_b64_tr_b16 v[54:55], v6 offset:4288
    ds_read_b64_tr_b16 v[56:57], v6 offset:768
    ds_read_b64_tr_b16 v[58:59], v6 offset:4416
    s_waitcnt lgkmcnt(12)
    ds_write_b128 v31, v[32:35] offset:0
    ds_read_b128 v[64:67], v8 offset:0
    s_waitcnt lgkmcnt(12)
    ds_write_b128 v31, v[36:39] offset:1152
    ds_read_b128 v[68:71], v8 offset:1152
    s_waitcnt lgkmcnt(12)
    ds_write_b128 v31, v[40:43] offset:2304
    ds_read_b128 v[72:75], v8 offset:2304
    s_waitcnt lgkmcnt(12)
    ds_write_b128 v31, v[44:47] offset:3456
    ds_read_b128 v[76:79], v8 offset:3456
    s_waitcnt lgkmcnt(12)
    ds_write_b128 v31, v[48:51] offset:4608
    ds_read_b128 v[80:83], v8 offset:4608
    s_waitcnt lgkmcnt(12)
    ds_write_b128 v31, v[52:55] offset:5760
    ds_read_b128 v[84:87], v8 offset:5760
    s_waitcnt lgkmcnt(12)
    ds_write_b128 v31, v[56:59] offset:6912
    ds_read_b128 v[88:91], v8 offset:6912
    s_waitcnt lgkmcnt(12)
    buffer_store_dwordx4 v[64:67], v7, s[52:55], s77 offen sc1
    s_add_u32 s77, s77, 262144
    s_waitcnt lgkmcnt(10)
    buffer_store_dwordx4 v[68:71], v7, s[52:55], s77 offen sc1
    s_add_u32 s77, s77, 262144
    s_waitcnt lgkmcnt(8)
    buffer_store_dwordx4 v[72:75], v7, s[52:55], s77 offen sc1
    s_add_u32 s77, s77, 262144
    s_waitcnt lgkmcnt(6)
    buffer_store_dwordx4 v[76:79], v7, s[52:55], s77 offen sc1
    s_add_u32 s77, s77, 262144
    s_waitcnt lgkmcnt(4)
    buffer_store_dwordx4 v[80:83], v7, s[52:55], s77 offen sc1
    s_add_u32 s77, s77, 262144
    s_waitcnt lgkmcnt(2)
    buffer_store_dwordx4 v[84:87], v7, s[52:55], s77 offen sc1
    s_add_u32 s77, s77, 262144
    s_waitcnt lgkmcnt(0)
    buffer_store_dwordx4 v[88:91], v7, s[52:55], s77 offen sc1
    s_cmp_lg_u32 s68, 1
    s_cbranch_scc1 PC_70
    s_waitcnt vmcnt(7)
    s_mov_b64 exec, 1
    buffer_store_dword v10, v29, s[52:55], 0 offen sc1
    s_mov_b64 exec, -1
    s_waitcnt vmcnt(1)
    s_branch PC_71
PC_70:
    s_waitcnt vmcnt(0)
PC_71:
    s_barrier
    s_cmp_lg_u32 s68, 1
    s_cbranch_scc1 K_END
    s_mov_b64 exec, 0xff
    buffer_store_dword v10, v28, s[52:55], 0 offen offset:0 sc1
    s_mov_b64 exec, -1
K_END:
    s_endpgm
.section .rodata,"a"
.p2align 6
.amdhsa_kernel parallel_sum__ssm_conv_s4__glu_gated_geglu__prompt_kernel
  .amdhsa_next_free_vgpr 256
  .amdhsa_next_free_sgpr 102
  .amdhsa_accum_offset 256
  .amdhsa_group_segment_fixed_size 0
  .amdhsa_kernarg_size 128
  .amdhsa_user_sgpr_count 2
  .amdhsa_user_sgpr_kernarg_segment_ptr 1
  .amdhsa_system_sgpr_workgroup_id_x 1
.end_amdhsa_kernel
```
